```python
import torch

def _softmax(x, axis=-1):
    return torch.softmax(x, dim=axis)
def _gelu(x):
    return torch.nn.functional.gelu(x, approximate="tanh")
def _silu(x):
    return torch.nn.functional.silu(x)
def _sigmoid(x):
    return torch.sigmoid(x)
def _layernorm(x, axis=-1, eps=1e-5):
    m = x.mean(dim=axis, keepdim=True)
    v = x.var(dim=axis, keepdim=True, unbiased=False)
    return (x - m) / torch.sqrt(v + eps)
def _scatter_add(tgt, idx, src, axis=0):
    return tgt.clone().index_add_(axis, idx, src)
def _segment_sum(src, seg, n):
    out = torch.zeros((n,) + src.shape[1:], dtype=src.dtype)
    return out.index_add_(0, seg, src)
def _pad(x, pw):
    flat = tuple(v for pair in reversed(pw) for v in pair)
    return torch.nn.functional.pad(x, flat)

kernel_name = 'gated_mix__gqa_block_cached__dense_activation_silu__decode'

def setup_inputs():

    _w = (lambda a: (lambda t: t.to(torch.bfloat16) if t.is_floating_point() else t)(torch.as_tensor(a)))
    def _A_setup():
        B, Sq, D = 4, 1, 640
        Hq, Hkv, Sk, Dh = 32, 32, 4096, 192
        assert Hq % Hkv == 0, (Hq, Hkv)
        return {
            "x": _w((lambda *s: torch.randn(*s, dtype=torch.bfloat16) * 0.1)(B, Sq, D)),
            "k_cache": _w((lambda *s: torch.randn(*s, dtype=torch.bfloat16) * 3.2)(B, Hkv, Sk, Dh)),
            "v_cache": _w((lambda *s: torch.randn(*s, dtype=torch.bfloat16) * 3.2)(B, Hkv, Sk, Dh)),
            "wq": _w((lambda *s: torch.randn(*s, dtype=torch.bfloat16) * 3.2)(D, Hq * Dh) * (D ** -0.5)),
            "wo": _w((lambda *s: torch.randn(*s, dtype=torch.bfloat16) * 3.2)(Hq * Dh, D) * ((Hq * Dh) ** -0.5)),
        }
    _A_in = _A_setup()

    def _B_setup():
        B, S, D, F = 4, 1, 640, 1536
        return {
            "x": _w((lambda *s: torch.randn(*s, dtype=torch.bfloat16) * 0.1)(B, S, D)),
            "w1": _w((lambda *s: torch.randn(*s, dtype=torch.bfloat16) * 3.2)(D, F) * (D ** -0.5)),
            "w2": _w((lambda *s: torch.randn(*s, dtype=torch.bfloat16) * 3.2)(F, D) * (F ** -0.5)),
        }
    _B_in = _B_setup()

    return {
        "A_x": _A_in["x"],
        "A_k_cache": _A_in["k_cache"],
        "A_v_cache": _A_in["v_cache"],
        "A_wq": _A_in["wq"],
        "A_wo": _A_in["wo"],
        "B_x": _B_in["x"],
        "B_w1": _B_in["w1"],
        "B_w2": _B_in["w2"],
        "gate_w": _w((lambda *s: torch.randn(*s, dtype=torch.bfloat16) * 0.1)(640) * 16.0),
    }

def reference(A_x, A_k_cache, A_v_cache, A_wq, A_wo, B_x, B_w1, B_w2, gate_w):
    def _A_ref(x, k_cache, v_cache, wq, wo):
        B, Sq, D = x.shape
        Hq, Dh = 32, 192
        Hkv = k_cache.shape[1]
        rep = Hq // Hkv
        q = (lambda x, *d: x.permute(*d))((x @ wq).reshape(B, Sq, Hq, Dh), 0, 2, 1, 3)
        k = (lambda x, n, axis: torch.repeat_interleave(x, n, dim=axis))(k_cache, rep, axis=1)
        v = (lambda x, n, axis: torch.repeat_interleave(x, n, dim=axis))(v_cache, rep, axis=1)
        scores = torch.einsum("bhqd,bhkd->bhqk", q, k) * (Dh ** -0.5)
        p = _softmax(scores, axis=-1)
        o = torch.einsum("bhqk,bhkd->bhqd", p, v)
        return (lambda x, *d: x.permute(*d))(o, 0, 2, 1, 3).reshape(B, Sq, Hq * Dh) @ wo

    def _B_ref(x, w1, w2):
        h = torch.einsum("bsd,df->bsf", x, w1)
        h = _silu(h)
        out = torch.einsum("bsf,fd->bsd", h, w2)
        return out

    x = A_x
    g = _sigmoid((x * gate_w).sum(-1, keepdims=True))
    a = _A_ref(x, A_k_cache, A_v_cache, A_wq, A_wo)
    b = _B_ref(x, B_w1, B_w2)
    return g * a + (1 - g) * b
```

```asm
; @launch grid=(256,1,1) block=(512,1,1) lds=91648
.amdgcn_target "amdgcn-amd-amdhsa--gfx950"
.text
.globl gated_mix__gqa_block_cached__dense_activation_silu__decode_kernel
.p2align 8
.type gated_mix__gqa_block_cached__dense_activation_silu__decode_kernel,@function
gated_mix__gqa_block_cached__dense_activation_silu__decode_kernel:
s_cmp_ge_u32 s2, 256
s_cbranch_scc1 L_end
s_load_dwordx16 s[16:31], s[0:1], 0
s_load_dwordx8 s[32:39], s[0:1], 64
v_lshrrev_b32 v1, 6, v0
v_lshlrev_b32 v11, 8, v0
v_readfirstlane_b32 s3, v1
v_and_b32 v0, 63, v0
s_and_b32 s8, s2, 7
s_lshr_b32 s9, s2, 3
s_and_b32 s10, s9, 7
s_lshr_b32 s4, s10, 1
s_and_b32 s6, s10, 1
s_lshr_b32 s5, s9, 3
s_lshl2_add_u32 s5, s8, s5
s_lshl_b32 s7, s5, 1
s_add_u32 s7, s7, s6
s_lshl_b32 s11, s4, 6
s_add_u32 s11, s11, s7
s_lshr_b32 s12, s11, 1
s_mul_i32 s12, s12, 1572864
s_lshl3_add_u32 s13, s6, s3
s_mul_i32 s13, s13, 768
s_add_u32 s12, s12, s13
s_mul_i32 s15, s11, 13
s_and_b32 s15, s15, 127
s_mul_i32 s15, s15, 12288
v_mul_u32_u24 v1, 12, v0
v_lshrrev_b32 v6, 5, v0
v_and_b32 v7, 31, v0
v_mul_u32_u24 v7, 12, v7
v_mul_u32_u24 v2, 491520, v6
v_add_u32 v2, v2, v7
v_mul_u32_u24 v10, 80, v6
s_mov_b32 s43, 0x20000
s_mov_b32 s51, 0x20000
s_mov_b32 s67, 0x20000
s_mov_b32 s42, 1561344
s_mov_b32 s50, 971136
s_mov_b32 s66, 160
s_lshl_b32 s7, s8, 3
s_lshr_b32 s9, s9, 3
s_lshl_b32 s9, s9, 1
s_add_u32 s7, s7, s9
s_add_u32 s7, s7, s6
s_mul_i32 s8, s3, 160
s_mul_i32 s9, s4, 1280
s_mul_i32 s13, s3, 983040
s_mul_i32 s10, s5, 384
s_add_u32 s13, s13, s10
s_add_u32 s10, s9, s8
s_waitcnt lgkmcnt(0)
s_add_u32 s40, s18, s12
s_addc_u32 s41, s19, 0
s_mov_b32 s18, s15
buffer_load_dwordx3 v[224:226], v1, s[40:43], s18 offen nt
s_add_u32 s18, s18, 12288
s_cmp_eq_u32 s18, 1572864
s_cselect_b32 s18, 0, s18
buffer_load_dwordx3 v[228:230], v1, s[40:43], s18 offen nt
s_add_u32 s18, s18, 12288
s_cmp_eq_u32 s18, 1572864
s_cselect_b32 s18, 0, s18
s_add_u32 s64, s16, s10
s_addc_u32 s65, s17, 0
s_add_u32 s48, s22, s13
s_addc_u32 s49, s23, 0
buffer_load_dwordx4 v[12:15], v10, s[64:67], 0 offen offset:0
buffer_load_dwordx4 v[16:19], v10, s[64:67], 0 offen offset:16
buffer_load_dwordx4 v[20:23], v10, s[64:67], 0 offen offset:32
buffer_load_dwordx4 v[24:27], v10, s[64:67], 0 offen offset:48
buffer_load_dwordx4 v[28:31], v10, s[64:67], 0 offen offset:64
s_mov_b32 s19, 0
buffer_load_dwordx3 v[32:34], v2, s[48:51], s19 offen
s_mov_b32 s19, 12288
buffer_load_dwordx3 v[36:38], v2, s[48:51], s19 offen
buffer_load_dwordx3 v[232:234], v1, s[40:43], s18 offen nt
s_add_u32 s18, s18, 12288
s_cmp_eq_u32 s18, 1572864
s_cselect_b32 s18, 0, s18
buffer_load_dwordx3 v[236:238], v1, s[40:43], s18 offen nt
s_add_u32 s18, s18, 12288
s_cmp_eq_u32 s18, 1572864
s_cselect_b32 s18, 0, s18
s_mov_b32 s96, 0x05040100
s_mov_b32 s97, 0x07060302
s_mov_b32 s98, 0xcccccccc
s_mov_b32 s99, 0xcccccccc
s_mov_b32 s100, 0xaaaaaaaa
s_mov_b32 s101, 0xaaaaaaaa
s_mov_b32 s47, 0x20000
s_mov_b32 s55, 0x20000
s_mov_b32 s59, 0x20000
s_mov_b32 s63, 0x20000
s_mov_b32 s71, 0x20000
s_mov_b32 s75, 0x20000
s_mov_b32 s79, 0x20000
s_mov_b32 s83, 0x20000
s_mov_b32 s87, 0x20000
s_mov_b32 s46, 1561344
s_mov_b32 s54, 244640
s_mul_i32 s13, s7, 48
s_sub_u32 s58, 1966080, s13
s_add_u32 s56, s28, s13
s_addc_u32 s57, s29, 0
s_mov_b32 s62, 29600
s_mov_b32 s70, 1280
s_mov_b32 s74, 1280
s_mov_b32 s78, 320
s_mov_b32 s82, 128
s_mov_b32 s86, 256
s_add_u32 s68, s16, s9
s_addc_u32 s69, s17, 0
s_add_u32 s72, s32, 0
s_addc_u32 s73, s33, 0
s_add_u32 s44, s20, s12
s_addc_u32 s45, s21, 0
s_mul_i32 s13, s5, 245760
s_add_u32 s13, s13, s8
s_add_u32 s52, s24, s13
s_addc_u32 s53, s25, 0
s_mul_i32 s13, s7, 30720
s_add_u32 s13, s13, s8
s_add_u32 s60, s30, s13
s_addc_u32 s61, s31, 0
s_mul_i32 s13, s11, 2560
s_lshl_b32 s14, s8, 1
s_add_u32 s13, s13, s14
s_add_u32 s76, s38, s13
s_addc_u32 s77, s39, 0
s_lshr_b32 s13, s11, 1
s_lshl_b32 s13, s13, 7
s_add_u32 s13, s13, 1048576
s_add_u32 s80, s38, s13
s_addc_u32 s81, s39, 0
s_add_u32 s84, s36, 0
s_addc_u32 s85, s37, 0
s_lshl_b32 m0, s3, 10
s_add_u32 m0, m0, 26112
v_mov_b32 v6, -1
v_mov_b32 v7, -1
v_mov_b32 v8, -1
v_mov_b32 v9, -1
v_lshlrev_b32 v10, 4, v0
s_lshl_b32 s13, s3, 1
s_add_u32 s13, s13, s6
s_lshl_b32 s13, s13, 6
v_lshl_add_u32 v5, v0, 3, s13
s_cmp_eq_u32 s3, 0
s_cselect_b32 s31, 4, 0
buffer_store_dwordx4 v[6:9], v10, s[76:79], 0 offen sc1
s_mov_b64 exec, 0xff
buffer_store_dwordx2 v[6:7], v5, s[80:83], 0 offen sc1
s_mov_b64 exec, -1
s_mov_b32 s19, 24576
buffer_load_dwordx3 v[40:42], v2, s[48:51], s19 offen
s_mov_b32 s19, 36864
buffer_load_dwordx3 v[44:46], v2, s[48:51], s19 offen
buffer_load_dwordx3 v[240:242], v1, s[40:43], s18 offen nt
s_add_u32 s18, s18, 12288
s_cmp_eq_u32 s18, 1572864
s_cselect_b32 s18, 0, s18
buffer_load_dwordx3 v[244:246], v1, s[40:43], s18 offen nt
s_add_u32 s18, s18, 12288
s_cmp_eq_u32 s18, 1572864
s_cselect_b32 s18, 0, s18
s_barrier
s_mov_b32 s19, 49152
buffer_load_dwordx3 v[48:50], v2, s[48:51], s19 offen
s_mov_b32 s19, 61440
buffer_load_dwordx3 v[52:54], v2, s[48:51], s19 offen
buffer_load_dwordx3 v[248:250], v1, s[40:43], s18 offen nt
s_add_u32 s18, s18, 12288
s_cmp_eq_u32 s18, 1572864
s_cselect_b32 s18, 0, s18
buffer_load_dwordx3 v[252:254], v1, s[40:43], s18 offen nt
s_add_u32 s18, s18, 12288
s_cmp_eq_u32 s18, 1572864
s_cselect_b32 s18, 0, s18
buffer_load_dwordx3 v[220:222], v1, s[40:43], s18 offen nt
s_add_u32 s18, s18, 12288
s_cmp_eq_u32 s18, 1572864
s_cselect_b32 s18, 0, s18
s_mov_b32 s19, 73728
buffer_load_dwordx3 v[56:58], v2, s[48:51], s19 offen
s_mov_b32 s19, 86016
buffer_load_dwordx3 v[60:62], v2, s[48:51], s19 offen
buffer_load_dwordx3 v[216:218], v1, s[40:43], s18 offen nt
s_add_u32 s18, s18, 12288
s_cmp_eq_u32 s18, 1572864
s_cselect_b32 s18, 0, s18
buffer_load_dwordx3 v[212:214], v1, s[40:43], s18 offen nt
s_add_u32 s18, s18, 12288
s_cmp_eq_u32 s18, 1572864
s_cselect_b32 s18, 0, s18
s_barrier
v_mov_b32 v6, 0
v_mov_b32 v7, 0
v_mov_b32 v8, 0
v_mov_b32 v9, 0
v_mov_b32 v219, 0
v_mov_b32 v223, 0
s_waitcnt vmcnt(17)
v_perm_b32 v195, v36, v32, s96
v_perm_b32 v199, v36, v32, s97
v_perm_b32 v203, v37, v33, s96
v_perm_b32 v207, v37, v33, s97
v_perm_b32 v211, v38, v34, s96
v_perm_b32 v215, v38, v34, s97
s_mov_b32 s19, 98304
buffer_load_dwordx3 v[32:34], v2, s[48:51], s19 offen
s_mov_b32 s19, 110592
buffer_load_dwordx3 v[36:38], v2, s[48:51], s19 offen
buffer_load_dwordx3 v[208:210], v1, s[40:43], s18 offen nt
s_add_u32 s18, s18, 12288
s_cmp_eq_u32 s18, 1572864
s_cselect_b32 s18, 0, s18
buffer_load_dwordx3 v[204:206], v1, s[40:43], s18 offen nt
s_add_u32 s18, s18, 12288
s_cmp_eq_u32 s18, 1572864
s_cselect_b32 s18, 0, s18
buffer_load_dwordx3 v[200:202], v1, s[40:43], s18 offen nt
s_add_u32 s18, s18, 12288
s_cmp_eq_u32 s18, 1572864
s_cselect_b32 s18, 0, s18
v_dot2c_f32_bf16 v6, v195, v12
v_dot2c_f32_bf16 v7, v199, v12
v_dot2c_f32_bf16 v8, v203, v12
v_dot2c_f32_bf16 v9, v207, v12
v_dot2c_f32_bf16 v219, v211, v12
v_dot2c_f32_bf16 v223, v215, v12
s_waitcnt vmcnt(16)
v_perm_b32 v195, v44, v40, s96
v_perm_b32 v199, v44, v40, s97
v_perm_b32 v203, v45, v41, s96
v_perm_b32 v207, v45, v41, s97
v_perm_b32 v211, v46, v42, s96
v_perm_b32 v215, v46, v42, s97
s_mov_b32 s19, 122880
buffer_load_dwordx3 v[40:42], v2, s[48:51], s19 offen
s_mov_b32 s19, 135168
buffer_load_dwordx3 v[44:46], v2, s[48:51], s19 offen
buffer_load_dwordx3 v[196:198], v1, s[40:43], s18 offen nt
s_add_u32 s18, s18, 12288
s_cmp_eq_u32 s18, 1572864
s_cselect_b32 s18, 0, s18
buffer_load_dwordx3 v[192:194], v1, s[40:43], s18 offen nt
s_add_u32 s18, s18, 12288
s_cmp_eq_u32 s18, 1572864
s_cselect_b32 s18, 0, s18
v_dot2c_f32_bf16 v6, v195, v13
v_dot2c_f32_bf16 v7, v199, v13
v_dot2c_f32_bf16 v8, v203, v13
v_dot2c_f32_bf16 v9, v207, v13
v_dot2c_f32_bf16 v219, v211, v13
v_dot2c_f32_bf16 v223, v215, v13
s_barrier
s_waitcnt vmcnt(16)
v_perm_b32 v195, v52, v48, s96
v_perm_b32 v199, v52, v48, s97
v_perm_b32 v203, v53, v49, s96
v_perm_b32 v207, v53, v49, s97
v_perm_b32 v211, v54, v50, s96
v_perm_b32 v215, v54, v50, s97
s_mov_b32 s19, 147456
buffer_load_dwordx3 v[48:50], v2, s[48:51], s19 offen
s_mov_b32 s19, 159744
buffer_load_dwordx3 v[52:54], v2, s[48:51], s19 offen
buffer_load_dwordx3 v[188:190], v1, s[40:43], s18 offen nt
s_add_u32 s18, s18, 12288
s_cmp_eq_u32 s18, 1572864
s_cselect_b32 s18, 0, s18
buffer_load_dwordx3 v[184:186], v1, s[40:43], s18 offen nt
s_add_u32 s18, s18, 12288
s_cmp_eq_u32 s18, 1572864
s_cselect_b32 s18, 0, s18
buffer_load_dwordx3 v[180:182], v1, s[40:43], s18 offen nt
s_add_u32 s18, s18, 12288
s_cmp_eq_u32 s18, 1572864
s_cselect_b32 s18, 0, s18
v_dot2c_f32_bf16 v6, v195, v14
v_dot2c_f32_bf16 v7, v199, v14
v_dot2c_f32_bf16 v8, v203, v14
v_dot2c_f32_bf16 v9, v207, v14
v_dot2c_f32_bf16 v219, v211, v14
v_dot2c_f32_bf16 v223, v215, v14
s_waitcnt vmcnt(16)
v_perm_b32 v195, v60, v56, s96
v_perm_b32 v199, v60, v56, s97
v_perm_b32 v203, v61, v57, s96
v_perm_b32 v207, v61, v57, s97
v_perm_b32 v211, v62, v58, s96
v_perm_b32 v215, v62, v58, s97
s_mov_b32 s19, 172032
buffer_load_dwordx3 v[56:58], v2, s[48:51], s19 offen
s_mov_b32 s19, 184320
buffer_load_dwordx3 v[60:62], v2, s[48:51], s19 offen
buffer_load_dwordx3 v[176:178], v1, s[40:43], s18 offen nt
s_add_u32 s18, s18, 12288
s_cmp_eq_u32 s18, 1572864
s_cselect_b32 s18, 0, s18
buffer_load_dwordx3 v[172:174], v1, s[40:43], s18 offen nt
s_add_u32 s18, s18, 12288
s_cmp_eq_u32 s18, 1572864
s_cselect_b32 s18, 0, s18
v_dot2c_f32_bf16 v6, v195, v15
v_dot2c_f32_bf16 v7, v199, v15
v_dot2c_f32_bf16 v8, v203, v15
v_dot2c_f32_bf16 v9, v207, v15
v_dot2c_f32_bf16 v219, v211, v15
v_dot2c_f32_bf16 v223, v215, v15
s_barrier
s_waitcnt vmcnt(16)
v_perm_b32 v195, v36, v32, s96
v_perm_b32 v199, v36, v32, s97
v_perm_b32 v203, v37, v33, s96
v_perm_b32 v207, v37, v33, s97
v_perm_b32 v211, v38, v34, s96
v_perm_b32 v215, v38, v34, s97
s_mov_b32 s19, 196608
buffer_load_dwordx3 v[32:34], v2, s[48:51], s19 offen
s_mov_b32 s19, 208896
buffer_load_dwordx3 v[36:38], v2, s[48:51], s19 offen
buffer_load_dwordx3 v[168:170], v1, s[40:43], s18 offen nt
s_add_u32 s18, s18, 12288
s_cmp_eq_u32 s18, 1572864
s_cselect_b32 s18, 0, s18
buffer_load_dwordx3 v[164:166], v1, s[40:43], s18 offen nt
s_add_u32 s18, s18, 12288
s_cmp_eq_u32 s18, 1572864
s_cselect_b32 s18, 0, s18
buffer_load_dwordx3 v[160:162], v1, s[40:43], s18 offen nt
s_add_u32 s18, s18, 12288
s_cmp_eq_u32 s18, 1572864
s_cselect_b32 s18, 0, s18
v_dot2c_f32_bf16 v6, v195, v16
v_dot2c_f32_bf16 v7, v199, v16
v_dot2c_f32_bf16 v8, v203, v16
v_dot2c_f32_bf16 v9, v207, v16
v_dot2c_f32_bf16 v219, v211, v16
v_dot2c_f32_bf16 v223, v215, v16
s_waitcnt vmcnt(16)
v_perm_b32 v195, v44, v40, s96
v_perm_b32 v199, v44, v40, s97
v_perm_b32 v203, v45, v41, s96
v_perm_b32 v207, v45, v41, s97
v_perm_b32 v211, v46, v42, s96
v_perm_b32 v215, v46, v42, s97
s_mov_b32 s19, 221184
buffer_load_dwordx3 v[40:42], v2, s[48:51], s19 offen
s_mov_b32 s19, 233472
buffer_load_dwordx3 v[44:46], v2, s[48:51], s19 offen
buffer_load_dwordx3 v[156:158], v1, s[40:43], s18 offen nt
s_add_u32 s18, s18, 12288
s_cmp_eq_u32 s18, 1572864
s_cselect_b32 s18, 0, s18
buffer_load_dwordx3 v[152:154], v1, s[40:43], s18 offen nt
s_add_u32 s18, s18, 12288
s_cmp_eq_u32 s18, 1572864
s_cselect_b32 s18, 0, s18
v_dot2c_f32_bf16 v6, v195, v17
v_dot2c_f32_bf16 v7, v199, v17
v_dot2c_f32_bf16 v8, v203, v17
v_dot2c_f32_bf16 v9, v207, v17
v_dot2c_f32_bf16 v219, v211, v17
v_dot2c_f32_bf16 v223, v215, v17
s_barrier
s_waitcnt vmcnt(16)
v_perm_b32 v195, v52, v48, s96
v_perm_b32 v199, v52, v48, s97
v_perm_b32 v203, v53, v49, s96
v_perm_b32 v207, v53, v49, s97
v_perm_b32 v211, v54, v50, s96
v_perm_b32 v215, v54, v50, s97
s_mov_b32 s19, 245760
buffer_load_dwordx3 v[48:50], v2, s[48:51], s19 offen
s_mov_b32 s19, 258048
buffer_load_dwordx3 v[52:54], v2, s[48:51], s19 offen
buffer_load_dwordx3 v[148:150], v1, s[40:43], s18 offen nt
s_add_u32 s18, s18, 12288
s_cmp_eq_u32 s18, 1572864
s_cselect_b32 s18, 0, s18
buffer_load_dwordx3 v[144:146], v1, s[40:43], s18 offen nt
s_add_u32 s18, s18, 12288
s_cmp_eq_u32 s18, 1572864
s_cselect_b32 s18, 0, s18
buffer_load_dwordx3 v[140:142], v1, s[40:43], s18 offen nt
s_add_u32 s18, s18, 12288
s_cmp_eq_u32 s18, 1572864
s_cselect_b32 s18, 0, s18
v_dot2c_f32_bf16 v6, v195, v18
v_dot2c_f32_bf16 v7, v199, v18
v_dot2c_f32_bf16 v8, v203, v18
v_dot2c_f32_bf16 v9, v207, v18
v_dot2c_f32_bf16 v219, v211, v18
v_dot2c_f32_bf16 v223, v215, v18
s_waitcnt vmcnt(16)
v_perm_b32 v195, v60, v56, s96
v_perm_b32 v199, v60, v56, s97
v_perm_b32 v203, v61, v57, s96
v_perm_b32 v207, v61, v57, s97
v_perm_b32 v211, v62, v58, s96
v_perm_b32 v215, v62, v58, s97
s_mov_b32 s19, 270336
buffer_load_dwordx3 v[56:58], v2, s[48:51], s19 offen
s_mov_b32 s19, 282624
buffer_load_dwordx3 v[60:62], v2, s[48:51], s19 offen
buffer_load_dwordx3 v[136:138], v1, s[40:43], s18 offen nt
s_add_u32 s18, s18, 12288
s_cmp_eq_u32 s18, 1572864
s_cselect_b32 s18, 0, s18
buffer_load_dwordx3 v[132:134], v1, s[40:43], s18 offen nt
s_add_u32 s18, s18, 12288
s_cmp_eq_u32 s18, 1572864
s_cselect_b32 s18, 0, s18
v_dot2c_f32_bf16 v6, v195, v19
v_dot2c_f32_bf16 v7, v199, v19
v_dot2c_f32_bf16 v8, v203, v19
v_dot2c_f32_bf16 v9, v207, v19
v_dot2c_f32_bf16 v219, v211, v19
v_dot2c_f32_bf16 v223, v215, v19
s_barrier
s_waitcnt vmcnt(16)
v_perm_b32 v195, v36, v32, s96
v_perm_b32 v199, v36, v32, s97
v_perm_b32 v203, v37, v33, s96
v_perm_b32 v207, v37, v33, s97
v_perm_b32 v211, v38, v34, s96
v_perm_b32 v215, v38, v34, s97
s_mov_b32 s19, 294912
buffer_load_dwordx3 v[32:34], v2, s[48:51], s19 offen
s_mov_b32 s19, 307200
buffer_load_dwordx3 v[36:38], v2, s[48:51], s19 offen
buffer_load_dwordx3 v[128:130], v1, s[40:43], s18 offen nt
s_add_u32 s18, s18, 12288
s_cmp_eq_u32 s18, 1572864
s_cselect_b32 s18, 0, s18
buffer_load_dwordx3 v[124:126], v1, s[40:43], s18 offen nt
s_add_u32 s18, s18, 12288
s_cmp_eq_u32 s18, 1572864
s_cselect_b32 s18, 0, s18
v_dot2c_f32_bf16 v6, v195, v20
v_dot2c_f32_bf16 v7, v199, v20
v_dot2c_f32_bf16 v8, v203, v20
v_dot2c_f32_bf16 v9, v207, v20
v_dot2c_f32_bf16 v219, v211, v20
v_dot2c_f32_bf16 v223, v215, v20
s_waitcnt vmcnt(15)
v_perm_b32 v195, v44, v40, s96
v_perm_b32 v199, v44, v40, s97
v_perm_b32 v203, v45, v41, s96
v_perm_b32 v207, v45, v41, s97
v_perm_b32 v211, v46, v42, s96
v_perm_b32 v215, v46, v42, s97
s_mov_b32 s19, 319488
buffer_load_dwordx3 v[40:42], v2, s[48:51], s19 offen
s_mov_b32 s19, 331776
buffer_load_dwordx3 v[44:46], v2, s[48:51], s19 offen
buffer_load_dwordx3 v[120:122], v1, s[40:43], s18 offen nt
s_add_u32 s18, s18, 12288
s_cmp_eq_u32 s18, 1572864
s_cselect_b32 s18, 0, s18
buffer_load_dwordx3 v[116:118], v1, s[40:43], s18 offen nt
s_add_u32 s18, s18, 12288
s_cmp_eq_u32 s18, 1572864
s_cselect_b32 s18, 0, s18
buffer_load_dwordx3 v[112:114], v1, s[40:43], s18 offen nt
s_add_u32 s18, s18, 12288
s_cmp_eq_u32 s18, 1572864
s_cselect_b32 s18, 0, s18
v_dot2c_f32_bf16 v6, v195, v21
v_dot2c_f32_bf16 v7, v199, v21
v_dot2c_f32_bf16 v8, v203, v21
v_dot2c_f32_bf16 v9, v207, v21
v_dot2c_f32_bf16 v219, v211, v21
v_dot2c_f32_bf16 v223, v215, v21
s_barrier
s_waitcnt vmcnt(16)
v_perm_b32 v195, v52, v48, s96
v_perm_b32 v199, v52, v48, s97
v_perm_b32 v203, v53, v49, s96
v_perm_b32 v207, v53, v49, s97
v_perm_b32 v211, v54, v50, s96
v_perm_b32 v215, v54, v50, s97
s_mov_b32 s19, 344064
buffer_load_dwordx3 v[48:50], v2, s[48:51], s19 offen
s_mov_b32 s19, 356352
buffer_load_dwordx3 v[52:54], v2, s[48:51], s19 offen
buffer_load_dwordx3 v[108:110], v1, s[40:43], s18 offen nt
s_add_u32 s18, s18, 12288
s_cmp_eq_u32 s18, 1572864
s_cselect_b32 s18, 0, s18
buffer_load_dwordx3 v[104:106], v1, s[40:43], s18 offen nt
s_add_u32 s18, s18, 12288
s_cmp_eq_u32 s18, 1572864
s_cselect_b32 s18, 0, s18
v_dot2c_f32_bf16 v6, v195, v22
v_dot2c_f32_bf16 v7, v199, v22
v_dot2c_f32_bf16 v8, v203, v22
v_dot2c_f32_bf16 v9, v207, v22
v_dot2c_f32_bf16 v219, v211, v22
v_dot2c_f32_bf16 v223, v215, v22
s_waitcnt vmcnt(15)
v_perm_b32 v195, v60, v56, s96
v_perm_b32 v199, v60, v56, s97
v_perm_b32 v203, v61, v57, s96
v_perm_b32 v207, v61, v57, s97
v_perm_b32 v211, v62, v58, s96
v_perm_b32 v215, v62, v58, s97
s_mov_b32 s19, 368640
buffer_load_dwordx3 v[56:58], v2, s[48:51], s19 offen
s_mov_b32 s19, 380928
buffer_load_dwordx3 v[60:62], v2, s[48:51], s19 offen
buffer_load_dwordx3 v[100:102], v1, s[40:43], s18 offen nt
s_add_u32 s18, s18, 12288
s_cmp_eq_u32 s18, 1572864
s_cselect_b32 s18, 0, s18
buffer_load_dwordx3 v[96:98], v1, s[40:43], s18 offen nt
s_add_u32 s18, s18, 12288
s_cmp_eq_u32 s18, 1572864
s_cselect_b32 s18, 0, s18
buffer_load_dwordx3 v[92:94], v1, s[40:43], s18 offen nt
s_add_u32 s18, s18, 12288
s_cmp_eq_u32 s18, 1572864
s_cselect_b32 s18, 0, s18
v_dot2c_f32_bf16 v6, v195, v23
v_dot2c_f32_bf16 v7, v199, v23
v_dot2c_f32_bf16 v8, v203, v23
v_dot2c_f32_bf16 v9, v207, v23
v_dot2c_f32_bf16 v219, v211, v23
v_dot2c_f32_bf16 v223, v215, v23
s_barrier
s_waitcnt vmcnt(16)
v_perm_b32 v195, v36, v32, s96
v_perm_b32 v199, v36, v32, s97
v_perm_b32 v203, v37, v33, s96
v_perm_b32 v207, v37, v33, s97
v_perm_b32 v211, v38, v34, s96
v_perm_b32 v215, v38, v34, s97
s_mov_b32 s19, 393216
buffer_load_dwordx3 v[32:34], v2, s[48:51], s19 offen
s_mov_b32 s19, 405504
buffer_load_dwordx3 v[36:38], v2, s[48:51], s19 offen
buffer_load_dwordx3 v[88:90], v1, s[40:43], s18 offen nt
s_add_u32 s18, s18, 12288
s_cmp_eq_u32 s18, 1572864
s_cselect_b32 s18, 0, s18
buffer_load_dwordx3 v[84:86], v1, s[40:43], s18 offen nt
s_add_u32 s18, s18, 12288
s_cmp_eq_u32 s18, 1572864
s_cselect_b32 s18, 0, s18
v_dot2c_f32_bf16 v6, v195, v24
v_dot2c_f32_bf16 v7, v199, v24
v_dot2c_f32_bf16 v8, v203, v24
v_dot2c_f32_bf16 v9, v207, v24
v_dot2c_f32_bf16 v219, v211, v24
v_dot2c_f32_bf16 v223, v215, v24
s_waitcnt vmcnt(16)
v_perm_b32 v195, v44, v40, s96
v_perm_b32 v199, v44, v40, s97
v_perm_b32 v203, v45, v41, s96
v_perm_b32 v207, v45, v41, s97
v_perm_b32 v211, v46, v42, s96
v_perm_b32 v215, v46, v42, s97
s_mov_b32 s19, 417792
buffer_load_dwordx3 v[40:42], v2, s[48:51], s19 offen
s_mov_b32 s19, 430080
buffer_load_dwordx3 v[44:46], v2, s[48:51], s19 offen
buffer_load_dwordx3 v[80:82], v1, s[40:43], s18 offen nt
s_add_u32 s18, s18, 12288
s_cmp_eq_u32 s18, 1572864
s_cselect_b32 s18, 0, s18
buffer_load_dwordx3 v[76:78], v1, s[40:43], s18 offen nt
s_add_u32 s18, s18, 12288
s_cmp_eq_u32 s18, 1572864
s_cselect_b32 s18, 0, s18
buffer_load_dwordx3 v[72:74], v1, s[40:43], s18 offen nt
s_add_u32 s18, s18, 12288
s_cmp_eq_u32 s18, 1572864
s_cselect_b32 s18, 0, s18
v_dot2c_f32_bf16 v6, v195, v25
v_dot2c_f32_bf16 v7, v199, v25
v_dot2c_f32_bf16 v8, v203, v25
v_dot2c_f32_bf16 v9, v207, v25
v_dot2c_f32_bf16 v219, v211, v25
v_dot2c_f32_bf16 v223, v215, v25
s_barrier
s_waitcnt vmcnt(16)
v_perm_b32 v195, v52, v48, s96
v_perm_b32 v199, v52, v48, s97
v_perm_b32 v203, v53, v49, s96
v_perm_b32 v207, v53, v49, s97
v_perm_b32 v211, v54, v50, s96
v_perm_b32 v215, v54, v50, s97
s_mov_b32 s19, 442368
buffer_load_dwordx3 v[48:50], v2, s[48:51], s19 offen
s_mov_b32 s19, 454656
buffer_load_dwordx3 v[52:54], v2, s[48:51], s19 offen
buffer_load_dwordx3 v[68:70], v1, s[40:43], s18 offen nt
s_add_u32 s18, s18, 12288
s_cmp_eq_u32 s18, 1572864
s_cselect_b32 s18, 0, s18
buffer_load_dwordx3 v[64:66], v1, s[40:43], s18 offen nt
s_add_u32 s18, s18, 12288
s_cmp_eq_u32 s18, 1572864
s_cselect_b32 s18, 0, s18
v_dot2c_f32_bf16 v6, v195, v26
v_dot2c_f32_bf16 v7, v199, v26
v_dot2c_f32_bf16 v8, v203, v26
v_dot2c_f32_bf16 v9, v207, v26
v_dot2c_f32_bf16 v219, v211, v26
v_dot2c_f32_bf16 v223, v215, v26
s_waitcnt vmcnt(16)
v_perm_b32 v195, v60, v56, s96
v_perm_b32 v199, v60, v56, s97
v_perm_b32 v203, v61, v57, s96
v_perm_b32 v207, v61, v57, s97
v_perm_b32 v211, v62, v58, s96
v_perm_b32 v215, v62, v58, s97
s_mov_b32 s19, 466944
buffer_load_dwordx3 v[56:58], v2, s[48:51], s19 offen
s_mov_b32 s19, 479232
buffer_load_dwordx3 v[60:62], v2, s[48:51], s19 offen
buffer_load_dwordx3 v1, s[40:43], s18 offen nt lds
s_add_u32 m0, m0, 8192
s_add_u32 s18, s18, 12288
s_cmp_eq_u32 s18, 1572864
s_cselect_b32 s18, 0, s18
buffer_load_dwordx3 v1, s[40:43], s18 offen nt lds
s_add_u32 m0, m0, 8192
s_add_u32 s18, s18, 12288
s_cmp_eq_u32 s18, 1572864
s_cselect_b32 s18, 0, s18
buffer_load_dwordx3 v1, s[40:43], s18 offen nt lds
s_add_u32 m0, m0, 8192
s_add_u32 s18, s18, 12288
s_cmp_eq_u32 s18, 1572864
s_cselect_b32 s18, 0, s18
v_dot2c_f32_bf16 v6, v195, v27
v_dot2c_f32_bf16 v7, v199, v27
v_dot2c_f32_bf16 v8, v203, v27
v_dot2c_f32_bf16 v9, v207, v27
v_dot2c_f32_bf16 v219, v211, v27
v_dot2c_f32_bf16 v223, v215, v27
s_barrier
s_waitcnt vmcnt(16)
v_perm_b32 v195, v36, v32, s96
v_perm_b32 v199, v36, v32, s97
v_perm_b32 v203, v37, v33, s96
v_perm_b32 v207, v37, v33, s97
v_perm_b32 v211, v38, v34, s96
v_perm_b32 v215, v38, v34, s97
buffer_load_dwordx3 v1, s[40:43], s18 offen nt lds
s_add_u32 m0, m0, 8192
s_add_u32 s18, s18, 12288
s_cmp_eq_u32 s18, 1572864
s_cselect_b32 s18, 0, s18
buffer_load_dwordx3 v1, s[40:43], s18 offen nt lds
s_add_u32 m0, m0, 8192
s_add_u32 s18, s18, 12288
s_cmp_eq_u32 s18, 1572864
s_cselect_b32 s18, 0, s18
v_dot2c_f32_bf16 v6, v195, v28
v_dot2c_f32_bf16 v7, v199, v28
v_dot2c_f32_bf16 v8, v203, v28
v_dot2c_f32_bf16 v9, v207, v28
v_dot2c_f32_bf16 v219, v211, v28
v_dot2c_f32_bf16 v223, v215, v28
s_waitcnt vmcnt(14)
v_perm_b32 v195, v44, v40, s96
v_perm_b32 v199, v44, v40, s97
v_perm_b32 v203, v45, v41, s96
v_perm_b32 v207, v45, v41, s97
v_perm_b32 v211, v46, v42, s96
v_perm_b32 v215, v46, v42, s97
buffer_load_dwordx3 v1, s[40:43], s18 offen nt lds
s_add_u32 m0, m0, 8192
s_add_u32 s18, s18, 12288
s_cmp_eq_u32 s18, 1572864
s_cselect_b32 s18, 0, s18
buffer_load_dwordx3 v1, s[40:43], s18 offen nt lds
s_add_u32 m0, m0, 8192
s_add_u32 s18, s18, 12288
s_cmp_eq_u32 s18, 1572864
s_cselect_b32 s18, 0, s18
buffer_load_dwordx3 v1, s[40:43], s18 offen nt lds
s_add_u32 m0, m0, 8192
s_add_u32 s18, s18, 12288
s_cmp_eq_u32 s18, 1572864
s_cselect_b32 s18, 0, s18
v_dot2c_f32_bf16 v6, v195, v29
v_dot2c_f32_bf16 v7, v199, v29
v_dot2c_f32_bf16 v8, v203, v29
v_dot2c_f32_bf16 v9, v207, v29
v_dot2c_f32_bf16 v219, v211, v29
v_dot2c_f32_bf16 v223, v215, v29
s_waitcnt vmcnt(12)
v_perm_b32 v195, v52, v48, s96
v_perm_b32 v199, v52, v48, s97
v_perm_b32 v203, v53, v49, s96
v_perm_b32 v207, v53, v49, s97
v_perm_b32 v211, v54, v50, s96
v_perm_b32 v215, v54, v50, s97
v_dot2c_f32_bf16 v6, v195, v30
v_dot2c_f32_bf16 v7, v199, v30
v_dot2c_f32_bf16 v8, v203, v30
v_dot2c_f32_bf16 v9, v207, v30
v_dot2c_f32_bf16 v219, v211, v30
v_dot2c_f32_bf16 v223, v215, v30
s_waitcnt vmcnt(8)
v_perm_b32 v195, v60, v56, s96
v_perm_b32 v199, v60, v56, s97
v_perm_b32 v203, v61, v57, s96
v_perm_b32 v207, v61, v57, s97
v_perm_b32 v211, v62, v58, s96
v_perm_b32 v215, v62, v58, s97
v_dot2c_f32_bf16 v6, v195, v31
v_dot2c_f32_bf16 v7, v199, v31
v_dot2c_f32_bf16 v8, v203, v31
v_dot2c_f32_bf16 v9, v207, v31
v_dot2c_f32_bf16 v219, v211, v31
v_dot2c_f32_bf16 v223, v215, v31
s_nop 0
v_permlane32_swap_b32 v6, v9
v_permlane32_swap_b32 v7, v219
v_permlane32_swap_b32 v8, v223
v_add_f32 v6, v6, v9
v_add_f32 v7, v7, v219
v_add_f32 v8, v8, v223
s_lshl_b32 s13, s3, 10
v_add_u32 v195, s13, v10
ds_write_b128 v195, v[6:9] offset:0
s_waitcnt lgkmcnt(0)
s_barrier
ds_read_b96 v[32:34], v10 offset:0
ds_read_b96 v[36:38], v10 offset:1024
ds_read_b96 v[40:42], v10 offset:2048
ds_read_b96 v[44:46], v10 offset:3072
ds_read_b96 v[48:50], v10 offset:4096
ds_read_b96 v[52:54], v10 offset:5120
ds_read_b96 v[56:58], v10 offset:6144
ds_read_b96 v[60:62], v10 offset:7168
v_mov_b32 v12, 1
s_and_b32 s13, s2, 63
s_lshl_b32 s13, s13, 2
buffer_atomic_add v12, v11, s[84:87], s13 offen sc1
v_and_b32 v13, 15, v0
v_lshrrev_b32 v14, 4, v0
v_and_b32 v15, 1, v0
v_mul_u32_u24 v16, 10, v13
v_and_b32 v16, -4, v16
v_mul_u32_u24 v2, 61440, v14
v_add_u32 v2, v2, v16
v_mul_u32_u24 v11, 7680, v14
v_add_u32 v11, v11, v16
v_lshlrev_b32 v31, 2, v0
s_waitcnt lgkmcnt(6)
v_add_f32 v32, v32, v36
v_add_f32 v33, v33, v37
v_add_f32 v34, v34, v38
s_waitcnt lgkmcnt(5)
v_add_f32 v32, v32, v40
v_add_f32 v33, v33, v41
v_add_f32 v34, v34, v42
s_waitcnt lgkmcnt(4)
v_add_f32 v32, v32, v44
v_add_f32 v33, v33, v45
v_add_f32 v34, v34, v46
s_waitcnt lgkmcnt(3)
v_add_f32 v32, v32, v48
v_add_f32 v33, v33, v49
v_add_f32 v34, v34, v50
s_waitcnt lgkmcnt(2)
v_add_f32 v32, v32, v52
v_add_f32 v33, v33, v53
v_add_f32 v34, v34, v54
s_waitcnt lgkmcnt(1)
v_add_f32 v32, v32, v56
v_add_f32 v33, v33, v57
v_add_f32 v34, v34, v58
s_waitcnt lgkmcnt(0)
v_add_f32 v32, v32, v60
v_add_f32 v33, v33, v61
v_add_f32 v34, v34, v62
v_mov_b32 v36, v32
v_mov_b32 v37, v33
v_mov_b32 v38, v34
v_permlane32_swap_b32 v32, v36
v_permlane32_swap_b32 v33, v37
v_permlane32_swap_b32 v34, v38
v_cvt_pk_bf16_f32 v20, v32, v33
v_cvt_pk_bf16_f32 v21, v34, v36
v_cvt_pk_bf16_f32 v22, v37, v38
s_lshl_b32 s13, s3, 10
s_add_u32 s13, s13, 26112
v_add_u32 v23, s13, v10
v_add_u32 v28, 0x10000, v23
v_dot2_f32_bf16 v195, v224, v20, 0
v_dot2_f32_bf16 v195, v225, v21, v195
v_dot2_f32_bf16 v195, v226, v22, v195
v_dot2_f32_bf16 v199, v228, v20, 0
v_dot2_f32_bf16 v199, v229, v21, v199
v_dot2_f32_bf16 v199, v230, v22, v199
v_dot2_f32_bf16 v203, v232, v20, 0
v_dot2_f32_bf16 v203, v233, v21, v203
v_dot2_f32_bf16 v203, v234, v22, v203
buffer_load_dwordx3 v[224:226], v1, s[40:43], s18 offen nt
s_add_u32 s18, s18, 12288
s_cmp_eq_u32 s18, 1572864
s_cselect_b32 s18, 0, s18
v_permlane16_swap_b32 v195, v199
v_add_f32 v211, v195, v199
v_dot2_f32_bf16 v207, v236, v20, 0
v_dot2_f32_bf16 v207, v237, v21, v207
v_dot2_f32_bf16 v207, v238, v22, v207
v_dot2_f32_bf16 v195, v240, v20, 0
v_dot2_f32_bf16 v195, v241, v21, v195
v_dot2_f32_bf16 v195, v242, v22, v195
v_permlane16_swap_b32 v203, v207
v_add_f32 v215, v203, v207
v_add_f32_dpp v219, v211, v211 row_ror:8 row_mask:0xf bank_mask:0x3
s_nop 1
v_add_f32_dpp v219, v215, v215 row_ror:8 row_mask:0xf bank_mask:0xc
v_dot2_f32_bf16 v199, v244, v20, 0
v_dot2_f32_bf16 v199, v245, v21, v199
v_dot2_f32_bf16 v199, v246, v22, v199
buffer_load_dwordx3 v[228:230], v1, s[40:43], s18 offen nt
s_add_u32 s18, s18, 12288
s_cmp_eq_u32 s18, 1572864
s_cselect_b32 s18, 0, s18
v_dot2_f32_bf16 v203, v248, v20, 0
v_dot2_f32_bf16 v203, v249, v21, v203
v_dot2_f32_bf16 v203, v250, v22, v203
v_permlane16_swap_b32 v195, v199
v_add_f32 v211, v195, v199
v_dot2_f32_bf16 v207, v252, v20, 0
v_dot2_f32_bf16 v207, v253, v21, v207
v_dot2_f32_bf16 v207, v254, v22, v207
v_dot2_f32_bf16 v195, v220, v20, 0
v_dot2_f32_bf16 v195, v221, v21, v195
v_dot2_f32_bf16 v195, v222, v22, v195
buffer_load_dwordx3 v[232:234], v1, s[40:43], s18 offen nt
s_add_u32 s18, s18, 12288
s_cmp_eq_u32 s18, 1572864
s_cselect_b32 s18, 0, s18
v_permlane16_swap_b32 v203, v207
v_add_f32 v215, v203, v207
v_add_f32_dpp v223, v211, v211 row_ror:8 row_mask:0xf bank_mask:0x3
s_nop 1
v_add_f32_dpp v223, v215, v215 row_ror:8 row_mask:0xf bank_mask:0xc
v_add_f32_dpp v227, v219, v219 row_shl:4 row_mask:0xf bank_mask:0x5
s_nop 1
v_add_f32_dpp v227, v223, v223 row_shr:4 row_mask:0xf bank_mask:0xa
s_nop 1
v_add_f32_dpp v227, v227, v227 quad_perm:[2,3,0,1] row_mask:0xf bank_mask:0xf
v_dot2_f32_bf16 v199, v216, v20, 0
v_dot2_f32_bf16 v199, v217, v21, v199
v_dot2_f32_bf16 v199, v218, v22, v199
v_dot2_f32_bf16 v203, v212, v20, 0
v_dot2_f32_bf16 v203, v213, v21, v203
v_dot2_f32_bf16 v203, v214, v22, v203
v_permlane16_swap_b32 v195, v199
v_add_f32 v211, v195, v199
v_dot2_f32_bf16 v207, v208, v20, 0
v_dot2_f32_bf16 v207, v209, v21, v207
v_dot2_f32_bf16 v207, v210, v22, v207
buffer_load_dwordx3 v[236:238], v1, s[40:43], s18 offen nt
s_add_u32 s18, s18, 12288
s_cmp_eq_u32 s18, 1572864
s_cselect_b32 s18, 0, s18
v_dot2_f32_bf16 v195, v204, v20, 0
v_dot2_f32_bf16 v195, v205, v21, v195
v_dot2_f32_bf16 v195, v206, v22, v195
v_permlane16_swap_b32 v203, v207
v_add_f32 v215, v203, v207
v_add_f32_dpp v219, v211, v211 row_ror:8 row_mask:0xf bank_mask:0x3
s_nop 1
v_add_f32_dpp v219, v215, v215 row_ror:8 row_mask:0xf bank_mask:0xc
v_dot2_f32_bf16 v199, v200, v20, 0
v_dot2_f32_bf16 v199, v201, v21, v199
v_dot2_f32_bf16 v199, v202, v22, v199
v_dot2_f32_bf16 v203, v196, v20, 0
v_dot2_f32_bf16 v203, v197, v21, v203
v_dot2_f32_bf16 v203, v198, v22, v203
buffer_load_dwordx3 v[240:242], v1, s[40:43], s18 offen nt
s_add_u32 s18, s18, 12288
s_cmp_eq_u32 s18, 1572864
s_cselect_b32 s18, 0, s18
v_permlane16_swap_b32 v195, v199
v_add_f32 v211, v195, v199
v_dot2_f32_bf16 v207, v192, v20, 0
v_dot2_f32_bf16 v207, v193, v21, v207
v_dot2_f32_bf16 v207, v194, v22, v207
s_barrier
v_dot2_f32_bf16 v195, v188, v20, 0
v_dot2_f32_bf16 v195, v189, v21, v195
v_dot2_f32_bf16 v195, v190, v22, v195
v_permlane16_swap_b32 v203, v207
v_add_f32 v215, v203, v207
v_add_f32_dpp v223, v211, v211 row_ror:8 row_mask:0xf bank_mask:0x3
s_nop 1
v_add_f32_dpp v223, v215, v215 row_ror:8 row_mask:0xf bank_mask:0xc
v_add_f32_dpp v231, v219, v219 row_shl:4 row_mask:0xf bank_mask:0x5
s_nop 1
v_add_f32_dpp v231, v223, v223 row_shr:4 row_mask:0xf bank_mask:0xa
s_nop 1
v_add_f32_dpp v231, v231, v231 quad_perm:[2,3,0,1] row_mask:0xf bank_mask:0xf
v_cndmask_b32_e64 v235, v227, v231, s[98:99]
s_nop 1
v_add_f32_dpp v235, v235, v235 quad_perm:[1,0,3,2] row_mask:0xf bank_mask:0xf
v_dot2_f32_bf16 v199, v184, v20, 0
v_dot2_f32_bf16 v199, v185, v21, v199
v_dot2_f32_bf16 v199, v186, v22, v199
buffer_load_dwordx3 v[244:246], v1, s[40:43], s18 offen nt
s_add_u32 s18, s18, 12288
s_cmp_eq_u32 s18, 1572864
s_cselect_b32 s18, 0, s18
v_dot2_f32_bf16 v203, v180, v20, 0
v_dot2_f32_bf16 v203, v181, v21, v203
v_dot2_f32_bf16 v203, v182, v22, v203
v_permlane16_swap_b32 v195, v199
v_add_f32 v211, v195, v199
v_dot2_f32_bf16 v207, v176, v20, 0
v_dot2_f32_bf16 v207, v177, v21, v207
v_dot2_f32_bf16 v207, v178, v22, v207
v_dot2_f32_bf16 v195, v172, v20, 0
v_dot2_f32_bf16 v195, v173, v21, v195
v_dot2_f32_bf16 v195, v174, v22, v195
buffer_load_dwordx3 v[248:250], v1, s[40:43], s18 offen nt
s_add_u32 s18, s18, 12288
s_cmp_eq_u32 s18, 1572864
s_cselect_b32 s18, 0, s18
v_permlane16_swap_b32 v203, v207
v_add_f32 v215, v203, v207
v_add_f32_dpp v219, v211, v211 row_ror:8 row_mask:0xf bank_mask:0x3
s_nop 1
v_add_f32_dpp v219, v215, v215 row_ror:8 row_mask:0xf bank_mask:0xc
v_dot2_f32_bf16 v199, v168, v20, 0
v_dot2_f32_bf16 v199, v169, v21, v199
v_dot2_f32_bf16 v199, v170, v22, v199
v_dot2_f32_bf16 v203, v164, v20, 0
v_dot2_f32_bf16 v203, v165, v21, v203
v_dot2_f32_bf16 v203, v166, v22, v203
v_permlane16_swap_b32 v195, v199
v_add_f32 v211, v195, v199
v_dot2_f32_bf16 v207, v160, v20, 0
v_dot2_f32_bf16 v207, v161, v21, v207
v_dot2_f32_bf16 v207, v162, v22, v207
buffer_load_dwordx3 v[252:254], v1, s[40:43], s18 offen nt
s_add_u32 s18, s18, 12288
s_cmp_eq_u32 s18, 1572864
s_cselect_b32 s18, 0, s18
v_dot2_f32_bf16 v195, v156, v20, 0
v_dot2_f32_bf16 v195, v157, v21, v195
v_dot2_f32_bf16 v195, v158, v22, v195
v_permlane16_swap_b32 v203, v207
v_add_f32 v215, v203, v207
v_add_f32_dpp v223, v211, v211 row_ror:8 row_mask:0xf bank_mask:0x3
s_nop 1
v_add_f32_dpp v223, v215, v215 row_ror:8 row_mask:0xf bank_mask:0xc
v_add_f32_dpp v227, v219, v219 row_shl:4 row_mask:0xf bank_mask:0x5
s_nop 1
v_add_f32_dpp v227, v223, v223 row_shr:4 row_mask:0xf bank_mask:0xa
s_nop 1
v_add_f32_dpp v227, v227, v227 quad_perm:[2,3,0,1] row_mask:0xf bank_mask:0xf
v_dot2_f32_bf16 v199, v152, v20, 0
v_dot2_f32_bf16 v199, v153, v21, v199
v_dot2_f32_bf16 v199, v154, v22, v199
v_dot2_f32_bf16 v203, v148, v20, 0
v_dot2_f32_bf16 v203, v149, v21, v203
v_dot2_f32_bf16 v203, v150, v22, v203
v_permlane16_swap_b32 v195, v199
v_add_f32 v211, v195, v199
v_dot2_f32_bf16 v207, v144, v20, 0
v_dot2_f32_bf16 v207, v145, v21, v207
v_dot2_f32_bf16 v207, v146, v22, v207
v_dot2_f32_bf16 v195, v140, v20, 0
v_dot2_f32_bf16 v195, v141, v21, v195
v_dot2_f32_bf16 v195, v142, v22, v195
v_permlane16_swap_b32 v203, v207
v_add_f32 v215, v203, v207
v_add_f32_dpp v219, v211, v211 row_ror:8 row_mask:0xf bank_mask:0x3
s_nop 1
v_add_f32_dpp v219, v215, v215 row_ror:8 row_mask:0xf bank_mask:0xc
v_dot2_f32_bf16 v199, v136, v20, 0
v_dot2_f32_bf16 v199, v137, v21, v199
v_dot2_f32_bf16 v199, v138, v22, v199
v_dot2_f32_bf16 v203, v132, v20, 0
v_dot2_f32_bf16 v203, v133, v21, v203
v_dot2_f32_bf16 v203, v134, v22, v203
v_permlane16_swap_b32 v195, v199
v_add_f32 v211, v195, v199
v_dot2_f32_bf16 v207, v128, v20, 0
v_dot2_f32_bf16 v207, v129, v21, v207
v_dot2_f32_bf16 v207, v130, v22, v207
s_barrier
v_dot2_f32_bf16 v195, v124, v20, 0
v_dot2_f32_bf16 v195, v125, v21, v195
v_dot2_f32_bf16 v195, v126, v22, v195
v_permlane16_swap_b32 v203, v207
v_add_f32 v215, v203, v207
v_add_f32_dpp v223, v211, v211 row_ror:8 row_mask:0xf bank_mask:0x3
s_nop 1
v_add_f32_dpp v223, v215, v215 row_ror:8 row_mask:0xf bank_mask:0xc
v_add_f32_dpp v231, v219, v219 row_shl:4 row_mask:0xf bank_mask:0x5
s_nop 1
v_add_f32_dpp v231, v223, v223 row_shr:4 row_mask:0xf bank_mask:0xa
s_nop 1
v_add_f32_dpp v231, v231, v231 quad_perm:[2,3,0,1] row_mask:0xf bank_mask:0xf
v_cndmask_b32_e64 v239, v227, v231, s[98:99]
s_nop 1
v_add_f32_dpp v239, v239, v239 quad_perm:[1,0,3,2] row_mask:0xf bank_mask:0xf
v_cndmask_b32_e64 v24, v235, v239, s[100:101]
v_dot2_f32_bf16 v199, v120, v20, 0
v_dot2_f32_bf16 v199, v121, v21, v199
v_dot2_f32_bf16 v199, v122, v22, v199
v_dot2_f32_bf16 v203, v116, v20, 0
v_dot2_f32_bf16 v203, v117, v21, v203
v_dot2_f32_bf16 v203, v118, v22, v203
v_permlane16_swap_b32 v195, v199
v_add_f32 v211, v195, v199
v_dot2_f32_bf16 v207, v112, v20, 0
v_dot2_f32_bf16 v207, v113, v21, v207
v_dot2_f32_bf16 v207, v114, v22, v207
v_dot2_f32_bf16 v195, v108, v20, 0
v_dot2_f32_bf16 v195, v109, v21, v195
v_dot2_f32_bf16 v195, v110, v22, v195
v_permlane16_swap_b32 v203, v207
v_add_f32 v215, v203, v207
v_add_f32_dpp v219, v211, v211 row_ror:8 row_mask:0xf bank_mask:0x3
s_nop 1
v_add_f32_dpp v219, v215, v215 row_ror:8 row_mask:0xf bank_mask:0xc
v_dot2_f32_bf16 v199, v104, v20, 0
v_dot2_f32_bf16 v199, v105, v21, v199
v_dot2_f32_bf16 v199, v106, v22, v199
v_dot2_f32_bf16 v203, v100, v20, 0
v_dot2_f32_bf16 v203, v101, v21, v203
v_dot2_f32_bf16 v203, v102, v22, v203
v_permlane16_swap_b32 v195, v199
v_add_f32 v211, v195, v199
v_dot2_f32_bf16 v207, v96, v20, 0
v_dot2_f32_bf16 v207, v97, v21, v207
v_dot2_f32_bf16 v207, v98, v22, v207
v_dot2_f32_bf16 v195, v92, v20, 0
v_dot2_f32_bf16 v195, v93, v21, v195
v_dot2_f32_bf16 v195, v94, v22, v195
v_permlane16_swap_b32 v203, v207
v_add_f32 v215, v203, v207
v_add_f32_dpp v223, v211, v211 row_ror:8 row_mask:0xf bank_mask:0x3
s_nop 1
v_add_f32_dpp v223, v215, v215 row_ror:8 row_mask:0xf bank_mask:0xc
v_add_f32_dpp v227, v219, v219 row_shl:4 row_mask:0xf bank_mask:0x5
s_nop 1
v_add_f32_dpp v227, v223, v223 row_shr:4 row_mask:0xf bank_mask:0xa
s_nop 1
v_add_f32_dpp v227, v227, v227 quad_perm:[2,3,0,1] row_mask:0xf bank_mask:0xf
v_lshrrev_b32 v6, 2, v0
v_mul_u32_u24 v6, 6, v6
s_mul_i32 s13, s3, 96
v_add_u32 v6, s13, v6
v_lshlrev_b32 v7, 1, v6
v_mul_u32_u24 v6, 3072, v6
v_and_b32 v8, 3, v0
v_mad_u32_u24 v6, v8, 12, v6
buffer_load_dwordx3 v[56:58], v7, s[68:71], 0 offen
buffer_load_dwordx3 v[60:62], v7, s[72:75], 0 offen
v_dot2_f32_bf16 v199, v88, v20, 0
v_dot2_f32_bf16 v199, v89, v21, v199
v_dot2_f32_bf16 v199, v90, v22, v199
s_mov_b32 s19, 0
buffer_load_dwordx3 v[32:34], v6, s[56:59], s19 offen
v_dot2_f32_bf16 v203, v84, v20, 0
v_dot2_f32_bf16 v203, v85, v21, v203
v_dot2_f32_bf16 v203, v86, v22, v203
v_permlane16_swap_b32 v195, v199
v_add_f32 v211, v195, v199
v_dot2_f32_bf16 v207, v80, v20, 0
v_dot2_f32_bf16 v207, v81, v21, v207
v_dot2_f32_bf16 v207, v82, v22, v207
s_mov_b32 s19, 3072
buffer_load_dwordx3 v[36:38], v6, s[56:59], s19 offen
v_dot2_f32_bf16 v195, v76, v20, 0
v_dot2_f32_bf16 v195, v77, v21, v195
v_dot2_f32_bf16 v195, v78, v22, v195
v_permlane16_swap_b32 v203, v207
v_add_f32 v215, v203, v207
v_add_f32_dpp v219, v211, v211 row_ror:8 row_mask:0xf bank_mask:0x3
s_nop 1
v_add_f32_dpp v219, v215, v215 row_ror:8 row_mask:0xf bank_mask:0xc
v_dot2_f32_bf16 v199, v72, v20, 0
v_dot2_f32_bf16 v199, v73, v21, v199
v_dot2_f32_bf16 v199, v74, v22, v199
s_mov_b32 s19, 6144
buffer_load_dwordx3 v[40:42], v6, s[56:59], s19 offen
s_waitcnt vmcnt(21)
ds_read_b96 v[220:222], v23 offset:0
v_dot2_f32_bf16 v203, v68, v20, 0
v_dot2_f32_bf16 v203, v69, v21, v203
v_dot2_f32_bf16 v203, v70, v22, v203
v_permlane16_swap_b32 v195, v199
v_add_f32 v211, v195, v199
s_waitcnt vmcnt(20)
ds_read_b96 v[216:218], v23 offset:8192
v_dot2_f32_bf16 v207, v64, v20, 0
v_dot2_f32_bf16 v207, v65, v21, v207
v_dot2_f32_bf16 v207, v66, v22, v207
s_mov_b32 s19, 9216
buffer_load_dwordx3 v[44:46], v6, s[56:59], s19 offen
s_barrier
s_waitcnt vmcnt(20)
ds_read_b96 v[212:214], v23 offset:16384
s_waitcnt lgkmcnt(2)
v_dot2_f32_bf16 v195, v220, v20, 0
v_dot2_f32_bf16 v195, v221, v21, v195
v_dot2_f32_bf16 v195, v222, v22, v195
v_permlane16_swap_b32 v203, v207
v_add_f32 v215, v203, v207
v_add_f32_dpp v223, v211, v211 row_ror:8 row_mask:0xf bank_mask:0x3
s_nop 1
v_add_f32_dpp v223, v215, v215 row_ror:8 row_mask:0xf bank_mask:0xc
v_add_f32_dpp v231, v219, v219 row_shl:4 row_mask:0xf bank_mask:0x5
s_nop 1
v_add_f32_dpp v231, v223, v223 row_shr:4 row_mask:0xf bank_mask:0xa
s_nop 1
v_add_f32_dpp v231, v231, v231 quad_perm:[2,3,0,1] row_mask:0xf bank_mask:0xf
v_cndmask_b32_e64 v235, v227, v231, s[98:99]
s_nop 1
v_add_f32_dpp v235, v235, v235 quad_perm:[1,0,3,2] row_mask:0xf bank_mask:0xf
s_waitcnt vmcnt(19)
ds_read_b96 v[208:210], v23 offset:24576
s_waitcnt lgkmcnt(2)
v_dot2_f32_bf16 v199, v216, v20, 0
v_dot2_f32_bf16 v199, v217, v21, v199
v_dot2_f32_bf16 v199, v218, v22, v199
s_mov_b32 s19, 12288
buffer_load_dwordx3 v[48:50], v6, s[56:59], s19 offen
s_waitcnt vmcnt(19)
ds_read_b96 v[204:206], v23 offset:32768
s_waitcnt lgkmcnt(2)
v_dot2_f32_bf16 v203, v212, v20, 0
v_dot2_f32_bf16 v203, v213, v21, v203
v_dot2_f32_bf16 v203, v214, v22, v203
v_permlane16_swap_b32 v195, v199
v_add_f32 v211, v195, v199
s_waitcnt vmcnt(18)
ds_read_b96 v[200:202], v23 offset:40960
s_waitcnt lgkmcnt(2)
v_dot2_f32_bf16 v207, v208, v20, 0
v_dot2_f32_bf16 v207, v209, v21, v207
v_dot2_f32_bf16 v207, v210, v22, v207
s_mov_b32 s19, 15360
buffer_load_dwordx3 v[52:54], v6, s[56:59], s19 offen
s_waitcnt vmcnt(18)
ds_read_b96 v[196:198], v23 offset:49152
s_waitcnt lgkmcnt(2)
v_dot2_f32_bf16 v195, v204, v20, 0
v_dot2_f32_bf16 v195, v205, v21, v195
v_dot2_f32_bf16 v195, v206, v22, v195
v_permlane16_swap_b32 v203, v207
v_add_f32 v215, v203, v207
v_add_f32_dpp v219, v211, v211 row_ror:8 row_mask:0xf bank_mask:0x3
s_nop 1
v_add_f32_dpp v219, v215, v215 row_ror:8 row_mask:0xf bank_mask:0xc
s_waitcnt vmcnt(17)
ds_read_b96 v[192:194], v23 offset:57344
s_waitcnt lgkmcnt(2)
v_dot2_f32_bf16 v199, v200, v20, 0
v_dot2_f32_bf16 v199, v201, v21, v199
v_dot2_f32_bf16 v199, v202, v22, v199
s_waitcnt lgkmcnt(1)
v_dot2_f32_bf16 v203, v196, v20, 0
v_dot2_f32_bf16 v203, v197, v21, v203
v_dot2_f32_bf16 v203, v198, v22, v203
v_permlane16_swap_b32 v195, v199
v_add_f32 v211, v195, v199
s_waitcnt lgkmcnt(0)
v_dot2_f32_bf16 v207, v192, v20, 0
v_dot2_f32_bf16 v207, v193, v21, v207
v_dot2_f32_bf16 v207, v194, v22, v207
s_waitcnt vmcnt(15)
v_dot2_f32_bf16 v195, v224, v20, 0
v_dot2_f32_bf16 v195, v225, v21, v195
v_dot2_f32_bf16 v195, v226, v22, v195
buffer_load_dwordx3 v[224:226], v1, s[40:43], s18 offen nt
s_add_u32 s18, s18, 12288
s_cmp_eq_u32 s18, 1572864
s_cselect_b32 s18, 0, s18
v_permlane16_swap_b32 v203, v207
v_add_f32 v215, v203, v207
v_add_f32_dpp v223, v211, v211 row_ror:8 row_mask:0xf bank_mask:0x3
s_nop 1
v_add_f32_dpp v223, v215, v215 row_ror:8 row_mask:0xf bank_mask:0xc
v_add_f32_dpp v227, v219, v219 row_shl:4 row_mask:0xf bank_mask:0x5
s_nop 1
v_add_f32_dpp v227, v223, v223 row_shr:4 row_mask:0xf bank_mask:0xa
s_nop 1
v_add_f32_dpp v227, v227, v227 quad_perm:[2,3,0,1] row_mask:0xf bank_mask:0xf
s_waitcnt vmcnt(15)
v_dot2_f32_bf16 v199, v228, v20, 0
v_dot2_f32_bf16 v199, v229, v21, v199
v_dot2_f32_bf16 v199, v230, v22, v199
buffer_load_dwordx3 v[228:230], v1, s[40:43], s18 offen nt
s_add_u32 s18, s18, 12288
s_cmp_eq_u32 s18, 1572864
s_cselect_b32 s18, 0, s18
s_waitcnt vmcnt(15)
v_dot2_f32_bf16 v203, v232, v20, 0
v_dot2_f32_bf16 v203, v233, v21, v203
v_dot2_f32_bf16 v203, v234, v22, v203
buffer_load_dwordx3 v[232:234], v1, s[40:43], s18 offen nt
s_add_u32 s18, s18, 12288
s_cmp_eq_u32 s18, 1572864
s_cselect_b32 s18, 0, s18
v_permlane16_swap_b32 v195, v199
v_add_f32 v211, v195, v199
s_waitcnt vmcnt(15)
v_dot2_f32_bf16 v207, v236, v20, 0
v_dot2_f32_bf16 v207, v237, v21, v207
v_dot2_f32_bf16 v207, v238, v22, v207
buffer_load_dwordx3 v[236:238], v1, s[40:43], s18 offen nt
s_add_u32 s18, s18, 12288
s_cmp_eq_u32 s18, 1572864
s_cselect_b32 s18, 0, s18
s_waitcnt vmcnt(15)
v_dot2_f32_bf16 v195, v240, v20, 0
v_dot2_f32_bf16 v195, v241, v21, v195
v_dot2_f32_bf16 v195, v242, v22, v195
buffer_load_dwordx3 v[240:242], v1, s[40:43], s18 offen nt
s_add_u32 s18, s18, 12288
s_cmp_eq_u32 s18, 1572864
s_cselect_b32 s18, 0, s18
v_permlane16_swap_b32 v203, v207
v_add_f32 v215, v203, v207
v_add_f32_dpp v219, v211, v211 row_ror:8 row_mask:0xf bank_mask:0x3
s_nop 1
v_add_f32_dpp v219, v215, v215 row_ror:8 row_mask:0xf bank_mask:0xc
s_mov_b32 s19, 0
buffer_load_dwordx3 v[192:194], v2, s[52:55], s19 offen
s_waitcnt vmcnt(16)
v_dot2_f32_bf16 v199, v244, v20, 0
v_dot2_f32_bf16 v199, v245, v21, v199
v_dot2_f32_bf16 v199, v246, v22, v199
buffer_load_dwordx3 v[244:246], v1, s[40:43], s18 offen nt
s_add_u32 s18, s18, 12288
s_cmp_eq_u32 s18, 1572864
s_cselect_b32 s18, 0, s18
s_waitcnt vmcnt(7)
v_perm_b32 v4, v36, v32, s96
v_perm_b32 v6, v36, v32, s97
v_perm_b32 v7, v37, v33, s96
v_perm_b32 v8, v37, v33, s97
v_perm_b32 v9, v38, v34, s96
v_perm_b32 v29, v38, v34, s97
v_dot2_f32_bf16 v35, v4, v56, 0
v_dot2_f32_bf16 v39, v6, v56, 0
v_dot2_f32_bf16 v43, v7, v56, 0
v_dot2_f32_bf16 v47, v8, v56, 0
v_dot2_f32_bf16 v51, v9, v56, 0
v_dot2_f32_bf16 v55, v29, v56, 0
v_perm_b32 v4, v44, v40, s96
v_perm_b32 v6, v44, v40, s97
v_perm_b32 v7, v45, v41, s96
v_perm_b32 v8, v45, v41, s97
v_perm_b32 v9, v46, v42, s96
v_perm_b32 v29, v46, v42, s97
v_dot2_f32_bf16 v35, v4, v57, v35
v_dot2_f32_bf16 v39, v6, v57, v39
v_dot2_f32_bf16 v43, v7, v57, v43
v_dot2_f32_bf16 v47, v8, v57, v47
v_dot2_f32_bf16 v51, v9, v57, v51
v_dot2_f32_bf16 v55, v29, v57, v55
v_perm_b32 v4, v52, v48, s96
v_perm_b32 v6, v52, v48, s97
v_perm_b32 v7, v53, v49, s96
v_perm_b32 v8, v53, v49, s97
v_perm_b32 v9, v54, v50, s96
v_perm_b32 v29, v54, v50, s97
v_dot2_f32_bf16 v35, v4, v58, v35
v_dot2_f32_bf16 v39, v6, v58, v39
v_dot2_f32_bf16 v43, v7, v58, v43
v_dot2_f32_bf16 v47, v8, v58, v47
v_dot2_f32_bf16 v51, v9, v58, v51
v_dot2_f32_bf16 v55, v29, v58, v55
s_mov_b32 s13, 0x3f803f80
s_mov_b32 s14, 0xffff0000
v_lshlrev_b32 v4, 16, v56
v_and_b32 v6, s14, v56
v_lshlrev_b32 v7, 16, v60
v_and_b32 v8, s14, v60
v_mul_f32 v4, v4, v7
v_mul_f32 v6, v6, v8
v_cvt_pk_bf16_f32 v9, v4, v6
v_dot2_f32_bf16 v59, v9, s13, 0
v_lshlrev_b32 v4, 16, v57
v_and_b32 v6, s14, v57
v_lshlrev_b32 v7, 16, v61
v_and_b32 v8, s14, v61
v_mul_f32 v4, v4, v7
v_mul_f32 v6, v6, v8
v_cvt_pk_bf16_f32 v9, v4, v6
v_dot2_f32_bf16 v59, v9, s13, v59
v_lshlrev_b32 v4, 16, v58
v_and_b32 v6, s14, v58
v_lshlrev_b32 v7, 16, v62
v_and_b32 v8, s14, v62
v_mul_f32 v4, v4, v7
v_mul_f32 v6, v6, v8
v_cvt_pk_bf16_f32 v9, v4, v6
v_dot2_f32_bf16 v59, v9, s13, v59
v_mov_b32 v63, 0
v_permlane32_swap_b32 v35, v51
v_permlane32_swap_b32 v39, v55
v_permlane32_swap_b32 v43, v59
v_permlane32_swap_b32 v47, v63
v_add_f32 v4, v35, v51
v_add_f32 v6, v39, v55
v_add_f32 v7, v43, v59
v_add_f32 v8, v47, v63
s_nop 0
v_permlane16_swap_b32 v4, v7
v_permlane16_swap_b32 v6, v8
v_add_f32 v4, v4, v7
v_add_f32 v6, v6, v8
v_lshrrev_b32 v7, 3, v0
v_lshlrev_b32 v7, 4, v7
v_add_f32_dpp v4, v4, v4 row_ror:8 row_mask:0xf bank_mask:0x3
v_and_b32 v8, 3, v0
v_lshl_add_u32 v7, v8, 2, v7
v_add_f32_dpp v4, v6, v6 row_ror:8 row_mask:0xf bank_mask:0xc
s_lshl_b32 s13, s3, 7
v_add_u32 v7, s13, v7
v_add_f32_dpp v6, v4, v4 row_shl:4 row_mask:0xf bank_mask:0x5
s_nop 1
v_add_f32_dpp v6, v4, v4 row_shr:4 row_mask:0xf bank_mask:0xa
ds_write_b32 v7, v6 offset:16384
s_waitcnt lgkmcnt(0)
v_dot2_f32_bf16 v203, v248, v20, 0
v_dot2_f32_bf16 v203, v249, v21, v203
v_dot2_f32_bf16 v203, v250, v22, v203
buffer_load_dwordx3 v[248:250], v1, s[40:43], s18 offen nt
s_add_u32 s18, s18, 12288
s_cmp_eq_u32 s18, 1572864
s_cselect_b32 s18, 0, s18
v_permlane16_swap_b32 v195, v199
v_add_f32 v211, v195, v199
buffer_load_dwordx3 v[32:34], v11, s[60:63], 0 offen offset:0
v_dot2_f32_bf16 v207, v252, v20, 0
v_dot2_f32_bf16 v207, v253, v21, v207
v_dot2_f32_bf16 v207, v254, v22, v207
buffer_load_dwordx3 v[252:254], v1, s[40:43], s18 offen nt
s_add_u32 s18, s18, 12288
s_cmp_eq_u32 s18, 1572864
s_cselect_b32 s18, 0, s18
buffer_load_dwordx3 v[36:38], v11, s[60:63], 0 offen offset:1280
s_mov_b32 s19, 1280
buffer_load_dwordx3 v[196:198], v2, s[52:55], s19 offen
s_barrier
s_waitcnt vmcnt(11)
v_dot2_f32_bf16 v195, v224, v20, 0
v_dot2_f32_bf16 v195, v225, v21, v195
v_dot2_f32_bf16 v195, v226, v22, v195
buffer_load_dwordx3 v[224:226], v1, s[40:43], s18 offen nt
s_add_u32 s18, s18, 12288
s_cmp_eq_u32 s18, 1572864
s_cselect_b32 s18, 0, s18
v_permlane16_swap_b32 v203, v207
v_add_f32 v215, v203, v207
v_add_f32_dpp v223, v211, v211 row_ror:8 row_mask:0xf bank_mask:0x3
s_nop 1
v_add_f32_dpp v223, v215, v215 row_ror:8 row_mask:0xf bank_mask:0xc
v_add_f32_dpp v231, v219, v219 row_shl:4 row_mask:0xf bank_mask:0x5
s_nop 1
v_add_f32_dpp v231, v223, v223 row_shr:4 row_mask:0xf bank_mask:0xa
s_nop 1
v_add_f32_dpp v231, v231, v231 quad_perm:[2,3,0,1] row_mask:0xf bank_mask:0xf
v_cndmask_b32_e64 v239, v227, v231, s[98:99]
s_nop 1
v_add_f32_dpp v239, v239, v239 quad_perm:[1,0,3,2] row_mask:0xf bank_mask:0xf
v_cndmask_b32_e64 v25, v235, v239, s[100:101]
buffer_load_dwordx3 v[40:42], v11, s[60:63], 0 offen offset:2560
s_waitcnt vmcnt(12)
v_dot2_f32_bf16 v199, v228, v20, 0
v_dot2_f32_bf16 v199, v229, v21, v199
v_dot2_f32_bf16 v199, v230, v22, v199
buffer_load_dwordx3 v[228:230], v1, s[40:43], s18 offen nt
s_add_u32 s18, s18, 12288
s_cmp_eq_u32 s18, 1572864
s_cselect_b32 s18, 0, s18
s_waitcnt vmcnt(12)
v_dot2_f32_bf16 v203, v232, v20, 0
v_dot2_f32_bf16 v203, v233, v21, v203
v_dot2_f32_bf16 v203, v234, v22, v203
buffer_load_dwordx3 v[232:234], v1, s[40:43], s18 offen nt
s_add_u32 s18, s18, 12288
s_cmp_eq_u32 s18, 1572864
s_cselect_b32 s18, 0, s18
v_permlane16_swap_b32 v195, v199
v_add_f32 v211, v195, v199
buffer_load_dwordx3 v[44:46], v11, s[60:63], 0 offen offset:3840
s_mov_b32 s19, 3840
buffer_load_dwordx3 v[200:202], v2, s[52:55], s19 offen
s_waitcnt vmcnt(14)
v_dot2_f32_bf16 v207, v236, v20, 0
v_dot2_f32_bf16 v207, v237, v21, v207
v_dot2_f32_bf16 v207, v238, v22, v207
buffer_load_dwordx3 v[236:238], v1, s[40:43], s18 offen nt
s_add_u32 s18, s18, 12288
s_cmp_eq_u32 s18, 1572864
s_cselect_b32 s18, 0, s18
s_mov_b32 s19, 5120
buffer_load_dwordx3 v[48:50], v11, s[60:63], s19 offen
s_waitcnt vmcnt(15)
v_dot2_f32_bf16 v195, v240, v20, 0
v_dot2_f32_bf16 v195, v241, v21, v195
v_dot2_f32_bf16 v195, v242, v22, v195
buffer_load_dwordx3 v[240:242], v1, s[40:43], s18 offen nt
s_add_u32 s18, s18, 12288
s_cmp_eq_u32 s18, 1572864
s_cselect_b32 s18, 0, s18
v_permlane16_swap_b32 v203, v207
v_add_f32 v215, v203, v207
v_add_f32_dpp v219, v211, v211 row_ror:8 row_mask:0xf bank_mask:0x3
s_nop 1
v_add_f32_dpp v219, v215, v215 row_ror:8 row_mask:0xf bank_mask:0xc
s_mov_b32 s19, 6400
buffer_load_dwordx3 v[52:54], v11, s[60:63], s19 offen
s_waitcnt vmcnt(15)
v_dot2_f32_bf16 v199, v244, v20, 0
v_dot2_f32_bf16 v199, v245, v21, v199
v_dot2_f32_bf16 v199, v246, v22, v199
buffer_load_dwordx3 v[244:246], v1, s[40:43], s18 offen nt
s_add_u32 s18, s18, 12288
s_cmp_eq_u32 s18, 1572864
s_cselect_b32 s18, 0, s18
s_mov_b32 s19, 5120
buffer_load_dwordx3 v[204:206], v2, s[52:55], s19 offen
s_waitcnt vmcnt(16)
v_dot2_f32_bf16 v203, v248, v20, 0
v_dot2_f32_bf16 v203, v249, v21, v203
v_dot2_f32_bf16 v203, v250, v22, v203
buffer_load_dwordx3 v[248:250], v1, s[40:43], s18 offen nt
s_add_u32 s18, s18, 12288
s_cmp_eq_u32 s18, 1572864
s_cselect_b32 s18, 0, s18
v_permlane16_swap_b32 v195, v199
v_add_f32 v211, v195, v199
s_waitcnt vmcnt(15)
v_dot2_f32_bf16 v207, v252, v20, 0
v_dot2_f32_bf16 v207, v253, v21, v207
v_dot2_f32_bf16 v207, v254, v22, v207
buffer_load_dwordx3 v[252:254], v1, s[40:43], s18 offen nt
s_add_u32 s18, s18, 12288
s_cmp_eq_u32 s18, 1572864
s_cselect_b32 s18, 0, s18
s_waitcnt vmcnt(13)
v_dot2_f32_bf16 v195, v224, v20, 0
v_dot2_f32_bf16 v195, v225, v21, v195
v_dot2_f32_bf16 v195, v226, v22, v195
buffer_load_dwordx3 v[224:226], v1, s[40:43], s18 offen nt
s_add_u32 s18, s18, 12288
s_cmp_eq_u32 s18, 1572864
s_cselect_b32 s18, 0, s18
v_permlane16_swap_b32 v203, v207
v_add_f32 v215, v203, v207
v_add_f32_dpp v223, v211, v211 row_ror:8 row_mask:0xf bank_mask:0x3
s_nop 1
v_add_f32_dpp v223, v215, v215 row_ror:8 row_mask:0xf bank_mask:0xc
v_add_f32_dpp v227, v219, v219 row_shl:4 row_mask:0xf bank_mask:0x5
s_nop 1
v_add_f32_dpp v227, v223, v223 row_shr:4 row_mask:0xf bank_mask:0xa
s_nop 1
v_add_f32_dpp v227, v227, v227 quad_perm:[2,3,0,1] row_mask:0xf bank_mask:0xf
s_mov_b32 s19, 2560
buffer_load_dwordx3 v[208:210], v2, s[52:55], s19 offen
s_waitcnt vmcnt(13)
v_dot2_f32_bf16 v199, v228, v20, 0
v_dot2_f32_bf16 v199, v229, v21, v199
v_dot2_f32_bf16 v199, v230, v22, v199
buffer_load_dwordx3 v[228:230], v1, s[40:43], s18 offen nt
s_add_u32 s18, s18, 12288
s_cmp_eq_u32 s18, 1572864
s_cselect_b32 s18, 0, s18
s_waitcnt vmcnt(13)
v_dot2_f32_bf16 v203, v232, v20, 0
v_dot2_f32_bf16 v203, v233, v21, v203
v_dot2_f32_bf16 v203, v234, v22, v203
buffer_load_dwordx3 v[232:234], v1, s[40:43], s18 offen nt
s_add_u32 s18, s18, 12288
s_cmp_eq_u32 s18, 1572864
s_cselect_b32 s18, 0, s18
v_permlane16_swap_b32 v195, v199
v_add_f32 v211, v195, v199
v_perm_b32 v64, v196, v192, s97
v_perm_b32 v72, v197, v193, s96
v_perm_b32 v80, v197, v193, s97
v_perm_b32 v96, v196, v192, s96
v_perm_b32 v193, v198, v194, s97
v_perm_b32 v88, v198, v194, s96
v_cndmask_b32_e64 v96, v96, v193, s[100:101]
s_waitcnt vmcnt(11)
v_dot2_f32_bf16 v207, v236, v20, 0
v_dot2_f32_bf16 v207, v237, v21, v207
v_dot2_f32_bf16 v207, v238, v22, v207
buffer_load_dwordx3 v[236:238], v1, s[40:43], s18 offen nt
s_add_u32 s18, s18, 12288
s_cmp_eq_u32 s18, 1572864
s_cselect_b32 s18, 0, s18
s_mov_b32 s19, 6400
buffer_load_dwordx3 v[212:214], v2, s[52:55], s19 offen
s_waitcnt vmcnt(11)
v_dot2_f32_bf16 v195, v240, v20, 0
v_dot2_f32_bf16 v195, v241, v21, v195
v_dot2_f32_bf16 v195, v242, v22, v195
buffer_load_dwordx3 v[240:242], v1, s[40:43], s18 offen nt
s_add_u32 s18, s18, 12288
s_cmp_eq_u32 s18, 1572864
s_cselect_b32 s18, 0, s18
v_permlane16_swap_b32 v203, v207
v_add_f32 v215, v203, v207
v_add_f32_dpp v219, v211, v211 row_ror:8 row_mask:0xf bank_mask:0x3
s_nop 1
v_add_f32_dpp v219, v215, v215 row_ror:8 row_mask:0xf bank_mask:0xc
s_waitcnt vmcnt(10)
v_dot2_f32_bf16 v199, v244, v20, 0
v_dot2_f32_bf16 v199, v245, v21, v199
v_dot2_f32_bf16 v199, v246, v22, v199
buffer_load_dwordx3 v[244:246], v1, s[40:43], s18 offen nt
s_add_u32 s18, s18, 12288
s_cmp_eq_u32 s18, 1572864
s_cselect_b32 s18, 0, s18
s_waitcnt vmcnt(9)
v_dot2_f32_bf16 v203, v248, v20, 0
v_dot2_f32_bf16 v203, v249, v21, v203
v_dot2_f32_bf16 v203, v250, v22, v203
buffer_load_dwordx3 v[248:250], v1, s[40:43], s18 offen nt
s_add_u32 s18, s18, 12288
s_cmp_eq_u32 s18, 1572864
s_cselect_b32 s18, 0, s18
v_permlane16_swap_b32 v195, v199
v_add_f32 v211, v195, v199
s_mov_b32 s19, 7680
buffer_load_dwordx3 v[216:218], v2, s[52:55], s19 offen
s_waitcnt vmcnt(10)
v_dot2_f32_bf16 v207, v252, v20, 0
v_dot2_f32_bf16 v207, v253, v21, v207
v_dot2_f32_bf16 v207, v254, v22, v207
buffer_load_dwordx3 v[252:254], v1, s[40:43], s18 offen nt
s_add_u32 s18, s18, 12288
s_cmp_eq_u32 s18, 1572864
s_cselect_b32 s18, 0, s18
v_and_b32 v4, 31, v0
v_lshlrev_b32 v4, 2, v4
ds_read_b32 v12, v4 offset:16384
ds_read_b32 v13, v4 offset:16512
ds_read_b32 v14, v4 offset:16640
ds_read_b32 v15, v4 offset:16768
ds_read_b32 v16, v4 offset:16896
ds_read_b32 v17, v4 offset:17024
ds_read_b32 v18, v4 offset:17152
ds_read_b32 v19, v4 offset:17280
v_and_b32 v6, 3, v0
v_lshlrev_b32 v6, 4, v6
v_bfe_u32 v7, v0, 2, 3
v_lshl_add_u32 v6, v7, 1, v6
s_lshl_b32 s13, s3, 6
v_add_u32 v6, s13, v6
v_and_b32 v4, 48, v0
v_add_u32 v4, s13, v4
s_waitcnt lgkmcnt(0)
v_add_f32 v12, v12, v13
v_add_f32 v12, v12, v14
v_add_f32 v12, v12, v15
v_add_f32 v12, v12, v16
v_add_f32 v12, v12, v17
v_add_f32 v12, v12, v18
v_add_f32 v12, v12, v19
v_cvt_pk_bf16_f32 v7, v12, v12
v_lshlrev_b32 v7, 16, v7
v_mul_f32 v8, 0xbfb8aa3b, v7
v_exp_f32 v8, v8
s_nop 0
v_add_f32 v8, 1.0, v8
v_rcp_f32 v8, v8
s_nop 0
v_mul_f32 v9, v7, v8
v_cvt_pk_bf16_f32 v9, v9, v9
ds_write_b16 v6, v9 offset:25600
v_cvt_pk_bf16_f32 v8, v8, v8
v_lshlrev_b32 v8, 16, v8
v_sub_f32 v29, 1.0, v8
v_cvt_pk_bf16_f32 v29, v29, v29
v_lshlrev_b32 v29, 16, v29
v_readlane_b32 s22, v8, 24
v_readlane_b32 s23, v29, 24
s_waitcnt lgkmcnt(0)
ds_read_b96 v[56:58], v4 offset:25600
s_waitcnt lgkmcnt(0)
v_perm_b32 v4, v36, v32, s97
v_perm_b32 v6, v37, v33, s96
v_perm_b32 v7, v37, v33, s97
v_perm_b32 v9, v36, v32, s96
v_perm_b32 v29, v38, v34, s97
v_perm_b32 v8, v38, v34, s96
v_cndmask_b32_e64 v9, v9, v29, s[100:101]
v_dot2_f32_bf16 v12, v4, v56, 0
v_dot2_f32_bf16 v13, v6, v56, 0
v_dot2_f32_bf16 v14, v7, v56, 0
v_dot2_f32_bf16 v15, v8, v56, 0
v_dot2_f32_bf16 v16, v9, v56, 0
v_perm_b32 v4, v44, v40, s97
v_perm_b32 v6, v45, v41, s96
v_perm_b32 v7, v45, v41, s97
v_perm_b32 v9, v44, v40, s96
v_perm_b32 v29, v46, v42, s97
v_perm_b32 v8, v46, v42, s96
v_cndmask_b32_e64 v9, v9, v29, s[100:101]
v_dot2_f32_bf16 v12, v4, v57, v12
v_dot2_f32_bf16 v13, v6, v57, v13
v_dot2_f32_bf16 v14, v7, v57, v14
v_dot2_f32_bf16 v15, v8, v57, v15
v_dot2_f32_bf16 v16, v9, v57, v16
v_perm_b32 v4, v52, v48, s97
v_perm_b32 v6, v53, v49, s96
v_perm_b32 v7, v53, v49, s97
v_perm_b32 v9, v52, v48, s96
v_perm_b32 v29, v54, v50, s97
v_perm_b32 v8, v54, v50, s96
v_cndmask_b32_e64 v9, v9, v29, s[100:101]
v_dot2_f32_bf16 v12, v4, v58, v12
v_dot2_f32_bf16 v13, v6, v58, v13
v_dot2_f32_bf16 v14, v7, v58, v14
v_dot2_f32_bf16 v15, v8, v58, v15
v_dot2_f32_bf16 v16, v9, v58, v16
v_mov_b32 v33, 0
v_mov_b32 v34, 0
v_mov_b32 v35, 0
v_mov_b32 v37, 0
v_mov_b32 v38, 0
v_mov_b32 v39, 0
v_mov_b32 v41, 0
v_mov_b32 v42, 0
v_mov_b32 v43, 0
v_mov_b32 v45, 0
v_mov_b32 v46, 0
v_mov_b32 v47, 0
v_mov_b32 v49, 0
v_mov_b32 v50, 0
v_mov_b32 v51, 0
v_mul_f32 v32, s23, v12
v_mul_f32 v36, s23, v13
v_mul_f32 v40, s23, v14
v_mul_f32 v44, s23, v15
v_mul_f32 v48, s23, v16
s_barrier
s_waitcnt vmcnt(10)
v_dot2_f32_bf16 v195, v224, v20, 0
v_dot2_f32_bf16 v195, v225, v21, v195
v_dot2_f32_bf16 v195, v226, v22, v195
buffer_load_dwordx3 v[224:226], v1, s[40:43], s18 offen nt
s_add_u32 s18, s18, 12288
s_cmp_eq_u32 s18, 1572864
s_cselect_b32 s18, 0, s18
v_permlane16_swap_b32 v203, v207
v_add_f32 v215, v203, v207
v_add_f32_dpp v223, v211, v211 row_ror:8 row_mask:0xf bank_mask:0x3
s_nop 1
v_add_f32_dpp v223, v215, v215 row_ror:8 row_mask:0xf bank_mask:0xc
v_add_f32_dpp v231, v219, v219 row_shl:4 row_mask:0xf bank_mask:0x5
s_nop 1
v_add_f32_dpp v231, v223, v223 row_shr:4 row_mask:0xf bank_mask:0xa
s_nop 1
v_add_f32_dpp v231, v231, v231 quad_perm:[2,3,0,1] row_mask:0xf bank_mask:0xf
v_cndmask_b32_e64 v235, v227, v231, s[98:99]
s_nop 1
v_add_f32_dpp v235, v235, v235 quad_perm:[1,0,3,2] row_mask:0xf bank_mask:0xf
v_perm_b32 v104, v204, v200, s97
v_perm_b32 v112, v205, v201, s96
v_perm_b32 v120, v205, v201, s97
v_perm_b32 v136, v204, v200, s96
v_perm_b32 v201, v206, v202, s97
v_perm_b32 v128, v206, v202, s96
v_cndmask_b32_e64 v136, v136, v201, s[100:101]
s_waitcnt vmcnt(9)
v_dot2_f32_bf16 v199, v228, v20, 0
v_dot2_f32_bf16 v199, v229, v21, v199
v_dot2_f32_bf16 v199, v230, v22, v199
buffer_load_dwordx3 v[228:230], v1, s[40:43], s18 offen nt
s_add_u32 s18, s18, 12288
s_cmp_eq_u32 s18, 1572864
s_cselect_b32 s18, 0, s18
s_mov_b32 s19, 8960
buffer_load_dwordx3 v[220:222], v2, s[52:55], s19 offen
s_waitcnt vmcnt(10)
v_dot2_f32_bf16 v203, v232, v20, 0
v_dot2_f32_bf16 v203, v233, v21, v203
v_dot2_f32_bf16 v203, v234, v22, v203
buffer_load_dwordx3 v[232:234], v1, s[40:43], s18 offen nt
s_add_u32 s18, s18, 12288
s_cmp_eq_u32 s18, 1572864
s_cselect_b32 s18, 0, s18
v_permlane16_swap_b32 v195, v199
v_add_f32 v211, v195, v199
s_waitcnt vmcnt(10)
v_dot2_f32_bf16 v207, v236, v20, 0
v_dot2_f32_bf16 v207, v237, v21, v207
v_dot2_f32_bf16 v207, v238, v22, v207
buffer_load_dwordx3 v[236:238], v1, s[40:43], s18 offen nt
s_add_u32 s18, s18, 12288
s_cmp_eq_u32 s18, 1572864
s_cselect_b32 s18, 0, s18
s_waitcnt vmcnt(9)
v_dot2_f32_bf16 v195, v240, v20, 0
v_dot2_f32_bf16 v195, v241, v21, v195
v_dot2_f32_bf16 v195, v242, v22, v195
buffer_load_dwordx3 v[240:242], v1, s[40:43], s18 offen nt
s_add_u32 s18, s18, 12288
s_cmp_eq_u32 s18, 1572864
s_cselect_b32 s18, 0, s18
v_permlane16_swap_b32 v203, v207
v_add_f32 v215, v203, v207
v_add_f32_dpp v219, v211, v211 row_ror:8 row_mask:0xf bank_mask:0x3
s_nop 1
v_add_f32_dpp v219, v215, v215 row_ror:8 row_mask:0xf bank_mask:0xc
s_mov_b32 s19, 11520
buffer_load_dwordx3 v[192:194], v2, s[52:55], s19 offen
s_waitcnt vmcnt(10)
v_dot2_f32_bf16 v199, v244, v20, 0
v_dot2_f32_bf16 v199, v245, v21, v199
v_dot2_f32_bf16 v199, v246, v22, v199
buffer_load_dwordx3 v[244:246], v1, s[40:43], s18 offen nt
s_add_u32 s18, s18, 12288
s_cmp_eq_u32 s18, 1572864
s_cselect_b32 s18, 0, s18
s_waitcnt vmcnt(10)
v_dot2_f32_bf16 v203, v248, v20, 0
v_dot2_f32_bf16 v203, v249, v21, v203
v_dot2_f32_bf16 v203, v250, v22, v203
buffer_load_dwordx3 v[248:250], v1, s[40:43], s18 offen nt
s_add_u32 s18, s18, 12288
s_cmp_eq_u32 s18, 1572864
s_cselect_b32 s18, 0, s18
v_permlane16_swap_b32 v195, v199
v_add_f32 v211, v195, v199
v_perm_b32 v144, v212, v208, s97
v_perm_b32 v152, v213, v209, s96
v_perm_b32 v160, v213, v209, s97
v_perm_b32 v176, v212, v208, s96
v_perm_b32 v209, v214, v210, s97
v_perm_b32 v168, v214, v210, s96
v_cndmask_b32_e64 v176, v176, v209, s[100:101]
s_waitcnt vmcnt(9)
v_dot2_f32_bf16 v207, v252, v20, 0
v_dot2_f32_bf16 v207, v253, v21, v207
v_dot2_f32_bf16 v207, v254, v22, v207
buffer_load_dwordx3 v[252:254], v1, s[40:43], s18 offen nt
s_add_u32 s18, s18, 12288
s_cmp_eq_u32 s18, 1572864
s_cselect_b32 s18, 0, s18
s_mov_b32 s19, 12800
buffer_load_dwordx3 v[196:198], v2, s[52:55], s19 offen
s_waitcnt vmcnt(10)
v_dot2_f32_bf16 v195, v224, v20, 0
v_dot2_f32_bf16 v195, v225, v21, v195
v_dot2_f32_bf16 v195, v226, v22, v195
buffer_load_dwordx3 v[224:226], v1, s[40:43], s18 offen nt
s_add_u32 s18, s18, 12288
s_cmp_eq_u32 s18, 1572864
s_cselect_b32 s18, 0, s18
v_permlane16_swap_b32 v203, v207
v_add_f32 v215, v203, v207
v_add_f32_dpp v223, v211, v211 row_ror:8 row_mask:0xf bank_mask:0x3
s_nop 1
v_add_f32_dpp v223, v215, v215 row_ror:8 row_mask:0xf bank_mask:0xc
v_add_f32_dpp v227, v219, v219 row_shl:4 row_mask:0xf bank_mask:0x5
s_nop 1
v_add_f32_dpp v227, v223, v223 row_shr:4 row_mask:0xf bank_mask:0xa
s_nop 1
v_add_f32_dpp v227, v227, v227 quad_perm:[2,3,0,1] row_mask:0xf bank_mask:0xf
s_waitcnt vmcnt(10)
v_dot2_f32_bf16 v199, v228, v20, 0
v_dot2_f32_bf16 v199, v229, v21, v199
v_dot2_f32_bf16 v199, v230, v22, v199
buffer_load_dwordx3 v[228:230], v1, s[40:43], s18 offen nt
s_add_u32 s18, s18, 12288
s_cmp_eq_u32 s18, 1572864
s_cselect_b32 s18, 0, s18
s_waitcnt vmcnt(9)
v_dot2_f32_bf16 v203, v232, v20, 0
v_dot2_f32_bf16 v203, v233, v21, v203
v_dot2_f32_bf16 v203, v234, v22, v203
buffer_load_dwordx3 v[232:234], v1, s[40:43], s18 offen nt
s_add_u32 s18, s18, 12288
s_cmp_eq_u32 s18, 1572864
s_cselect_b32 s18, 0, s18
v_permlane16_swap_b32 v195, v199
v_add_f32 v211, v195, v199
s_mov_b32 s19, 10240
buffer_load_dwordx3 v[200:202], v2, s[52:55], s19 offen
s_waitcnt vmcnt(10)
v_dot2_f32_bf16 v207, v236, v20, 0
v_dot2_f32_bf16 v207, v237, v21, v207
v_dot2_f32_bf16 v207, v238, v22, v207
buffer_load_dwordx3 v[236:238], v1, s[40:43], s18 offen nt
s_add_u32 s18, s18, 12288
s_cmp_eq_u32 s18, 1572864
s_cselect_b32 s18, 0, s18
s_waitcnt vmcnt(10)
v_dot2_f32_bf16 v195, v240, v20, 0
v_dot2_f32_bf16 v195, v241, v21, v195
v_dot2_f32_bf16 v195, v242, v22, v195
buffer_load_dwordx3 v[240:242], v1, s[40:43], s18 offen nt
s_add_u32 s18, s18, 12288
s_cmp_eq_u32 s18, 1572864
s_cselect_b32 s18, 0, s18
v_permlane16_swap_b32 v203, v207
v_add_f32 v215, v203, v207
v_add_f32_dpp v219, v211, v211 row_ror:8 row_mask:0xf bank_mask:0x3
s_nop 1
v_add_f32_dpp v219, v215, v215 row_ror:8 row_mask:0xf bank_mask:0xc
v_perm_b32 v65, v220, v216, s97
v_perm_b32 v73, v221, v217, s96
v_perm_b32 v81, v221, v217, s97
v_perm_b32 v97, v220, v216, s96
v_perm_b32 v217, v222, v218, s97
v_perm_b32 v89, v222, v218, s96
v_cndmask_b32_e64 v97, v97, v217, s[100:101]
s_waitcnt vmcnt(9)
v_dot2_f32_bf16 v199, v244, v20, 0
v_dot2_f32_bf16 v199, v245, v21, v199
v_dot2_f32_bf16 v199, v246, v22, v199
buffer_load_dwordx3 v[244:246], v1, s[40:43], s18 offen nt
s_add_u32 s18, s18, 12288
s_cmp_eq_u32 s18, 1572864
s_cselect_b32 s18, 0, s18
s_mov_b32 s19, 14080
buffer_load_dwordx3 v[204:206], v2, s[52:55], s19 offen
s_waitcnt vmcnt(10)
v_dot2_f32_bf16 v203, v248, v20, 0
v_dot2_f32_bf16 v203, v249, v21, v203
v_dot2_f32_bf16 v203, v250, v22, v203
buffer_load_dwordx3 v[248:250], v1, s[40:43], s18 offen nt
s_add_u32 s18, s18, 12288
s_cmp_eq_u32 s18, 1572864
s_cselect_b32 s18, 0, s18
v_permlane16_swap_b32 v195, v199
v_add_f32 v211, v195, v199
s_waitcnt vmcnt(10)
v_dot2_f32_bf16 v207, v252, v20, 0
v_dot2_f32_bf16 v207, v253, v21, v207
v_dot2_f32_bf16 v207, v254, v22, v207
buffer_load_dwordx3 v[252:254], v1, s[40:43], s18 offen nt
s_add_u32 s18, s18, 12288
s_cmp_eq_u32 s18, 1572864
s_cselect_b32 s18, 0, s18
s_barrier
s_waitcnt vmcnt(9)
v_dot2_f32_bf16 v195, v224, v20, 0
v_dot2_f32_bf16 v195, v225, v21, v195
v_dot2_f32_bf16 v195, v226, v22, v195
buffer_load_dwordx3 v[224:226], v1, s[40:43], s18 offen nt
s_add_u32 s18, s18, 12288
s_cmp_eq_u32 s18, 1572864
s_cselect_b32 s18, 0, s18
v_permlane16_swap_b32 v203, v207
v_add_f32 v215, v203, v207
v_add_f32_dpp v223, v211, v211 row_ror:8 row_mask:0xf bank_mask:0x3
s_nop 1
v_add_f32_dpp v223, v215, v215 row_ror:8 row_mask:0xf bank_mask:0xc
v_add_f32_dpp v231, v219, v219 row_shl:4 row_mask:0xf bank_mask:0x5
s_nop 1
v_add_f32_dpp v231, v223, v223 row_shr:4 row_mask:0xf bank_mask:0xa
s_nop 1
v_add_f32_dpp v231, v231, v231 quad_perm:[2,3,0,1] row_mask:0xf bank_mask:0xf
v_cndmask_b32_e64 v239, v227, v231, s[98:99]
s_nop 1
v_add_f32_dpp v239, v239, v239 quad_perm:[1,0,3,2] row_mask:0xf bank_mask:0xf
v_cndmask_b32_e64 v26, v235, v239, s[100:101]
s_mov_b32 s19, 15360
buffer_load_dwordx3 v[208:210], v2, s[52:55], s19 offen
s_waitcnt vmcnt(10)
v_dot2_f32_bf16 v199, v228, v20, 0
v_dot2_f32_bf16 v199, v229, v21, v199
v_dot2_f32_bf16 v199, v230, v22, v199
buffer_load_dwordx3 v[228:230], v1, s[40:43], s18 offen nt
s_add_u32 s18, s18, 12288
s_cmp_eq_u32 s18, 1572864
s_cselect_b32 s18, 0, s18
s_waitcnt vmcnt(10)
v_dot2_f32_bf16 v203, v232, v20, 0
v_dot2_f32_bf16 v203, v233, v21, v203
v_dot2_f32_bf16 v203, v234, v22, v203
buffer_load_dwordx3 v[232:234], v1, s[40:43], s18 offen nt
s_add_u32 s18, s18, 12288
s_cmp_eq_u32 s18, 1572864
s_cselect_b32 s18, 0, s18
v_permlane16_swap_b32 v195, v199
v_add_f32 v211, v195, v199
v_perm_b32 v105, v196, v192, s97
v_perm_b32 v113, v197, v193, s96
v_perm_b32 v121, v197, v193, s97
v_perm_b32 v137, v196, v192, s96
v_perm_b32 v193, v198, v194, s97
v_perm_b32 v129, v198, v194, s96
v_cndmask_b32_e64 v137, v137, v193, s[100:101]
s_waitcnt vmcnt(9)
v_dot2_f32_bf16 v207, v236, v20, 0
v_dot2_f32_bf16 v207, v237, v21, v207
v_dot2_f32_bf16 v207, v238, v22, v207
buffer_load_dwordx3 v[236:238], v1, s[40:43], s18 offen nt
s_add_u32 s18, s18, 12288
s_cmp_eq_u32 s18, 1572864
s_cselect_b32 s18, 0, s18
s_mov_b32 s19, 16640
buffer_load_dwordx3 v[212:214], v2, s[52:55], s19 offen
s_waitcnt vmcnt(10)
v_dot2_f32_bf16 v195, v240, v20, 0
v_dot2_f32_bf16 v195, v241, v21, v195
v_dot2_f32_bf16 v195, v242, v22, v195
buffer_load_dwordx3 v[240:242], v1, s[40:43], s18 offen nt
s_add_u32 s18, s18, 12288
s_cmp_eq_u32 s18, 1572864
s_cselect_b32 s18, 0, s18
v_permlane16_swap_b32 v203, v207
v_add_f32 v215, v203, v207
v_add_f32_dpp v219, v211, v211 row_ror:8 row_mask:0xf bank_mask:0x3
s_nop 1
v_add_f32_dpp v219, v215, v215 row_ror:8 row_mask:0xf bank_mask:0xc
s_waitcnt vmcnt(10)
v_dot2_f32_bf16 v199, v244, v20, 0
v_dot2_f32_bf16 v199, v245, v21, v199
v_dot2_f32_bf16 v199, v246, v22, v199
buffer_load_dwordx3 v[244:246], v1, s[40:43], s18 offen nt
s_add_u32 s18, s18, 12288
s_cmp_eq_u32 s18, 1572864
s_cselect_b32 s18, 0, s18
s_waitcnt vmcnt(9)
v_dot2_f32_bf16 v203, v248, v20, 0
v_dot2_f32_bf16 v203, v249, v21, v203
v_dot2_f32_bf16 v203, v250, v22, v203
buffer_load_dwordx3 v[248:250], v1, s[40:43], s18 offen nt
s_add_u32 s18, s18, 12288
s_cmp_eq_u32 s18, 1572864
s_cselect_b32 s18, 0, s18
v_permlane16_swap_b32 v195, v199
v_add_f32 v211, v195, v199
s_mov_b32 s19, 19200
buffer_load_dwordx3 v[216:218], v2, s[52:55], s19 offen
s_waitcnt vmcnt(10)
v_dot2_f32_bf16 v207, v252, v20, 0
v_dot2_f32_bf16 v207, v253, v21, v207
v_dot2_f32_bf16 v207, v254, v22, v207
buffer_load_dwordx3 v[252:254], v1, s[40:43], s18 offen nt
s_add_u32 s18, s18, 12288
s_cmp_eq_u32 s18, 1572864
s_cselect_b32 s18, 0, s18
s_waitcnt vmcnt(10)
v_dot2_f32_bf16 v195, v224, v20, 0
v_dot2_f32_bf16 v195, v225, v21, v195
v_dot2_f32_bf16 v195, v226, v22, v195
buffer_load_dwordx3 v[224:226], v1, s[40:43], s18 offen nt
s_add_u32 s18, s18, 12288
s_cmp_eq_u32 s18, 1572864
s_cselect_b32 s18, 0, s18
v_permlane16_swap_b32 v203, v207
v_add_f32 v215, v203, v207
v_add_f32_dpp v223, v211, v211 row_ror:8 row_mask:0xf bank_mask:0x3
s_nop 1
v_add_f32_dpp v223, v215, v215 row_ror:8 row_mask:0xf bank_mask:0xc
v_add_f32_dpp v227, v219, v219 row_shl:4 row_mask:0xf bank_mask:0x5
s_nop 1
v_add_f32_dpp v227, v223, v223 row_shr:4 row_mask:0xf bank_mask:0xa
s_nop 1
v_add_f32_dpp v227, v227, v227 quad_perm:[2,3,0,1] row_mask:0xf bank_mask:0xf
v_perm_b32 v145, v204, v200, s97
v_perm_b32 v153, v205, v201, s96
v_perm_b32 v161, v205, v201, s97
v_perm_b32 v177, v204, v200, s96
v_perm_b32 v201, v206, v202, s97
v_perm_b32 v169, v206, v202, s96
v_cndmask_b32_e64 v177, v177, v201, s[100:101]
s_waitcnt vmcnt(9)
v_dot2_f32_bf16 v199, v228, v20, 0
v_dot2_f32_bf16 v199, v229, v21, v199
v_dot2_f32_bf16 v199, v230, v22, v199
buffer_load_dwordx3 v[228:230], v1, s[40:43], s18 offen nt
s_add_u32 s18, s18, 12288
s_cmp_eq_u32 s18, 1572864
s_cselect_b32 s18, 0, s18
s_mov_b32 s19, 20480
buffer_load_dwordx3 v[220:222], v2, s[52:55], s19 offen
s_waitcnt vmcnt(10)
v_dot2_f32_bf16 v203, v232, v20, 0
v_dot2_f32_bf16 v203, v233, v21, v203
v_dot2_f32_bf16 v203, v234, v22, v203
buffer_load_dwordx3 v[232:234], v1, s[40:43], s18 offen nt
s_add_u32 s18, s18, 12288
s_cmp_eq_u32 s18, 1572864
s_cselect_b32 s18, 0, s18
v_permlane16_swap_b32 v195, v199
v_add_f32 v211, v195, v199
s_waitcnt vmcnt(10)
v_dot2_f32_bf16 v207, v236, v20, 0
v_dot2_f32_bf16 v207, v237, v21, v207
v_dot2_f32_bf16 v207, v238, v22, v207
buffer_load_dwordx3 v[236:238], v1, s[40:43], s18 offen nt
s_add_u32 s18, s18, 12288
s_cmp_eq_u32 s18, 1572864
s_cselect_b32 s18, 0, s18
s_waitcnt vmcnt(9)
v_dot2_f32_bf16 v195, v240, v20, 0
v_dot2_f32_bf16 v195, v241, v21, v195
v_dot2_f32_bf16 v195, v242, v22, v195
buffer_load_dwordx3 v[240:242], v1, s[40:43], s18 offen nt
s_add_u32 s18, s18, 12288
s_cmp_eq_u32 s18, 1572864
s_cselect_b32 s18, 0, s18
v_permlane16_swap_b32 v203, v207
v_add_f32 v215, v203, v207
v_add_f32_dpp v219, v211, v211 row_ror:8 row_mask:0xf bank_mask:0x3
s_nop 1
v_add_f32_dpp v219, v215, v215 row_ror:8 row_mask:0xf bank_mask:0xc
s_mov_b32 s19, 17920
buffer_load_dwordx3 v[192:194], v2, s[52:55], s19 offen
s_waitcnt vmcnt(10)
v_dot2_f32_bf16 v199, v244, v20, 0
v_dot2_f32_bf16 v199, v245, v21, v199
v_dot2_f32_bf16 v199, v246, v22, v199
buffer_load_dwordx3 v[244:246], v1, s[40:43], s18 offen nt
s_add_u32 s18, s18, 12288
s_cmp_eq_u32 s18, 1572864
s_cselect_b32 s18, 0, s18
s_waitcnt vmcnt(10)
v_dot2_f32_bf16 v203, v248, v20, 0
v_dot2_f32_bf16 v203, v249, v21, v203
v_dot2_f32_bf16 v203, v250, v22, v203
buffer_load_dwordx3 v[248:250], v1, s[40:43], s18 offen nt
s_add_u32 s18, s18, 12288
s_cmp_eq_u32 s18, 1572864
s_cselect_b32 s18, 0, s18
v_permlane16_swap_b32 v195, v199
v_add_f32 v211, v195, v199
v_perm_b32 v66, v212, v208, s97
v_perm_b32 v74, v213, v209, s96
v_perm_b32 v82, v213, v209, s97
v_perm_b32 v98, v212, v208, s96
v_perm_b32 v209, v214, v210, s97
v_perm_b32 v90, v214, v210, s96
v_cndmask_b32_e64 v98, v98, v209, s[100:101]
s_waitcnt vmcnt(9)
v_dot2_f32_bf16 v207, v252, v20, 0
v_dot2_f32_bf16 v207, v253, v21, v207
v_dot2_f32_bf16 v207, v254, v22, v207
buffer_load_dwordx3 v[252:254], v1, s[40:43], s18 offen nt
s_add_u32 s18, s18, 12288
s_cmp_eq_u32 s18, 1572864
s_cselect_b32 s18, 0, s18
s_mov_b32 s19, 21760
buffer_load_dwordx3 v[196:198], v2, s[52:55], s19 offen
s_barrier
s_waitcnt vmcnt(10)
v_dot2_f32_bf16 v195, v224, v20, 0
v_dot2_f32_bf16 v195, v225, v21, v195
v_dot2_f32_bf16 v195, v226, v22, v195
buffer_load_dwordx3 v[224:226], v1, s[40:43], s18 offen nt
s_add_u32 s18, s18, 12288
s_cmp_eq_u32 s18, 1572864
s_cselect_b32 s18, 0, s18
v_permlane16_swap_b32 v203, v207
v_add_f32 v215, v203, v207
v_add_f32_dpp v223, v211, v211 row_ror:8 row_mask:0xf bank_mask:0x3
s_nop 1
v_add_f32_dpp v223, v215, v215 row_ror:8 row_mask:0xf bank_mask:0xc
v_add_f32_dpp v231, v219, v219 row_shl:4 row_mask:0xf bank_mask:0x5
s_nop 1
v_add_f32_dpp v231, v223, v223 row_shr:4 row_mask:0xf bank_mask:0xa
s_nop 1
v_add_f32_dpp v231, v231, v231 quad_perm:[2,3,0,1] row_mask:0xf bank_mask:0xf
v_cndmask_b32_e64 v235, v227, v231, s[98:99]
s_nop 1
v_add_f32_dpp v235, v235, v235 quad_perm:[1,0,3,2] row_mask:0xf bank_mask:0xf
s_waitcnt vmcnt(10)
v_dot2_f32_bf16 v199, v228, v20, 0
v_dot2_f32_bf16 v199, v229, v21, v199
v_dot2_f32_bf16 v199, v230, v22, v199
buffer_load_dwordx3 v[228:230], v1, s[40:43], s18 offen nt
s_add_u32 s18, s18, 12288
s_cmp_eq_u32 s18, 1572864
s_cselect_b32 s18, 0, s18
s_waitcnt vmcnt(9)
v_dot2_f32_bf16 v203, v232, v20, 0
v_dot2_f32_bf16 v203, v233, v21, v203
v_dot2_f32_bf16 v203, v234, v22, v203
buffer_load_dwordx3 v[232:234], v1, s[40:43], s18 offen nt
s_add_u32 s18, s18, 12288
s_cmp_eq_u32 s18, 1572864
s_cselect_b32 s18, 0, s18
v_permlane16_swap_b32 v195, v199
v_add_f32 v211, v195, v199
s_mov_b32 s19, 23040
buffer_load_dwordx3 v[200:202], v2, s[52:55], s19 offen
s_waitcnt vmcnt(10)
v_dot2_f32_bf16 v207, v236, v20, 0
v_dot2_f32_bf16 v207, v237, v21, v207
v_dot2_f32_bf16 v207, v238, v22, v207
buffer_load_dwordx3 v[236:238], v1, s[40:43], s18 offen nt
s_add_u32 s18, s18, 12288
s_cmp_eq_u32 s18, 1572864
s_cselect_b32 s18, 0, s18
s_waitcnt vmcnt(10)
v_dot2_f32_bf16 v195, v240, v20, 0
v_dot2_f32_bf16 v195, v241, v21, v195
v_dot2_f32_bf16 v195, v242, v22, v195
buffer_load_dwordx3 v[240:242], v1, s[40:43], s18 offen nt
s_add_u32 s18, s18, 12288
s_cmp_eq_u32 s18, 1572864
s_cselect_b32 s18, 0, s18
v_permlane16_swap_b32 v203, v207
v_add_f32 v215, v203, v207
v_add_f32_dpp v219, v211, v211 row_ror:8 row_mask:0xf bank_mask:0x3
s_nop 1
v_add_f32_dpp v219, v215, v215 row_ror:8 row_mask:0xf bank_mask:0xc
v_perm_b32 v106, v220, v216, s97
v_perm_b32 v114, v221, v217, s96
v_perm_b32 v122, v221, v217, s97
v_perm_b32 v138, v220, v216, s96
v_perm_b32 v217, v222, v218, s97
v_perm_b32 v130, v222, v218, s96
v_cndmask_b32_e64 v138, v138, v217, s[100:101]
s_waitcnt vmcnt(9)
v_dot2_f32_bf16 v199, v244, v20, 0
v_dot2_f32_bf16 v199, v245, v21, v199
v_dot2_f32_bf16 v199, v246, v22, v199
buffer_load_dwordx3 v[244:246], v1, s[40:43], s18 offen nt
s_add_u32 s18, s18, 12288
s_cmp_eq_u32 s18, 1572864
s_cselect_b32 s18, 0, s18
s_mov_b32 s19, 24320
buffer_load_dwordx3 v[204:206], v2, s[52:55], s19 offen
s_waitcnt vmcnt(10)
v_dot2_f32_bf16 v203, v248, v20, 0
v_dot2_f32_bf16 v203, v249, v21, v203
v_dot2_f32_bf16 v203, v250, v22, v203
buffer_load_dwordx3 v[248:250], v1, s[40:43], s18 offen nt
s_add_u32 s18, s18, 12288
s_cmp_eq_u32 s18, 1572864
s_cselect_b32 s18, 0, s18
v_permlane16_swap_b32 v195, v199
v_add_f32 v211, v195, v199
s_waitcnt vmcnt(10)
v_dot2_f32_bf16 v207, v252, v20, 0
v_dot2_f32_bf16 v207, v253, v21, v207
v_dot2_f32_bf16 v207, v254, v22, v207
buffer_load_dwordx3 v[252:254], v1, s[40:43], s18 offen nt
s_add_u32 s18, s18, 12288
s_cmp_eq_u32 s18, 1572864
s_cselect_b32 s18, 0, s18
s_waitcnt vmcnt(9)
v_dot2_f32_bf16 v195, v224, v20, 0
v_dot2_f32_bf16 v195, v225, v21, v195
v_dot2_f32_bf16 v195, v226, v22, v195
buffer_load_dwordx3 v[224:226], v1, s[44:47], s18 offen nt
s_add_u32 s18, s18, 12288
s_cmp_eq_u32 s18, 1572864
s_cselect_b32 s18, 0, s18
v_permlane16_swap_b32 v203, v207
v_add_f32 v215, v203, v207
v_add_f32_dpp v223, v211, v211 row_ror:8 row_mask:0xf bank_mask:0x3
s_nop 1
v_add_f32_dpp v223, v215, v215 row_ror:8 row_mask:0xf bank_mask:0xc
v_add_f32_dpp v227, v219, v219 row_shl:4 row_mask:0xf bank_mask:0x5
s_nop 1
v_add_f32_dpp v227, v223, v223 row_shr:4 row_mask:0xf bank_mask:0xa
s_nop 1
v_add_f32_dpp v227, v227, v227 quad_perm:[2,3,0,1] row_mask:0xf bank_mask:0xf
s_mov_b32 s19, 26880
buffer_load_dwordx3 v[208:210], v2, s[52:55], s19 offen
s_waitcnt vmcnt(10)
v_dot2_f32_bf16 v199, v228, v20, 0
v_dot2_f32_bf16 v199, v229, v21, v199
v_dot2_f32_bf16 v199, v230, v22, v199
buffer_load_dwordx3 v[228:230], v1, s[44:47], s18 offen nt
s_add_u32 s18, s18, 12288
s_cmp_eq_u32 s18, 1572864
s_cselect_b32 s18, 0, s18
s_waitcnt vmcnt(10)
v_dot2_f32_bf16 v203, v232, v20, 0
v_dot2_f32_bf16 v203, v233, v21, v203
v_dot2_f32_bf16 v203, v234, v22, v203
buffer_load_dwordx3 v[232:234], v1, s[44:47], s18 offen nt
s_add_u32 s18, s18, 12288
s_cmp_eq_u32 s18, 1572864
s_cselect_b32 s18, 0, s18
v_permlane16_swap_b32 v195, v199
v_add_f32 v211, v195, v199
v_perm_b32 v146, v196, v192, s97
v_perm_b32 v154, v197, v193, s96
v_perm_b32 v162, v197, v193, s97
v_perm_b32 v178, v196, v192, s96
v_perm_b32 v193, v198, v194, s97
v_perm_b32 v170, v198, v194, s96
v_cndmask_b32_e64 v178, v178, v193, s[100:101]
s_waitcnt vmcnt(9)
v_dot2_f32_bf16 v207, v236, v20, 0
v_dot2_f32_bf16 v207, v237, v21, v207
v_dot2_f32_bf16 v207, v238, v22, v207
buffer_load_dwordx3 v[236:238], v1, s[44:47], s18 offen nt
s_add_u32 s18, s18, 12288
s_cmp_eq_u32 s18, 1572864
s_cselect_b32 s18, 0, s18
s_mov_b32 s19, 28160
buffer_load_dwordx3 v[212:214], v2, s[52:55], s19 offen
s_waitcnt vmcnt(10)
v_dot2_f32_bf16 v195, v240, v20, 0
v_dot2_f32_bf16 v195, v241, v21, v195
v_dot2_f32_bf16 v195, v242, v22, v195
buffer_load_dwordx3 v[240:242], v1, s[44:47], s18 offen nt
s_add_u32 s18, s18, 12288
s_cmp_eq_u32 s18, 1572864
s_cselect_b32 s18, 0, s18
v_permlane16_swap_b32 v203, v207
v_add_f32 v215, v203, v207
v_add_f32_dpp v219, v211, v211 row_ror:8 row_mask:0xf bank_mask:0x3
s_nop 1
v_add_f32_dpp v219, v215, v215 row_ror:8 row_mask:0xf bank_mask:0xc
s_waitcnt vmcnt(10)
v_dot2_f32_bf16 v199, v244, v20, 0
v_dot2_f32_bf16 v199, v245, v21, v199
v_dot2_f32_bf16 v199, v246, v22, v199
buffer_load_dwordx3 v[244:246], v1, s[44:47], s18 offen nt
s_add_u32 s18, s18, 12288
s_cmp_eq_u32 s18, 1572864
s_cselect_b32 s18, 0, s18
s_waitcnt vmcnt(9)
v_dot2_f32_bf16 v203, v248, v20, 0
v_dot2_f32_bf16 v203, v249, v21, v203
v_dot2_f32_bf16 v203, v250, v22, v203
buffer_load_dwordx3 v[248:250], v1, s[44:47], s18 offen nt
s_add_u32 s18, s18, 12288
s_cmp_eq_u32 s18, 1572864
s_cselect_b32 s18, 0, s18
v_permlane16_swap_b32 v195, v199
v_add_f32 v211, v195, v199
s_mov_b32 s19, 25600
buffer_load_dwordx3 v[216:218], v2, s[52:55], s19 offen
s_waitcnt vmcnt(10)
v_dot2_f32_bf16 v207, v252, v20, 0
v_dot2_f32_bf16 v207, v253, v21, v207
v_dot2_f32_bf16 v207, v254, v22, v207
buffer_load_dwordx3 v[252:254], v1, s[44:47], s18 offen nt
s_add_u32 s18, s18, 12288
s_cmp_eq_u32 s18, 1572864
s_cselect_b32 s18, 0, s18
v_permlane16_swap_b32 v203, v207
v_add_f32 v215, v203, v207
v_add_f32_dpp v223, v211, v211 row_ror:8 row_mask:0xf bank_mask:0x3
s_nop 1
v_add_f32_dpp v223, v215, v215 row_ror:8 row_mask:0xf bank_mask:0xc
v_add_f32_dpp v231, v219, v219 row_shl:4 row_mask:0xf bank_mask:0x5
s_nop 1
v_add_f32_dpp v231, v223, v223 row_shr:4 row_mask:0xf bank_mask:0xa
s_nop 1
v_add_f32_dpp v231, v231, v231 quad_perm:[2,3,0,1] row_mask:0xf bank_mask:0xf
v_cndmask_b32_e64 v239, v227, v231, s[98:99]
s_nop 1
v_add_f32_dpp v239, v239, v239 quad_perm:[1,0,3,2] row_mask:0xf bank_mask:0xf
v_cndmask_b32_e64 v27, v235, v239, s[100:101]
s_barrier
s_mov_b32 s14, 0xffff0000
v_cvt_pk_bf16_f32 v6, v24, v25
v_lshlrev_b32 v24, 16, v6
v_and_b32 v25, s14, v6
v_mul_f32 v24, 0x3d93cd3a, v24
v_mul_f32 v25, 0x3d93cd3a, v25
v_cvt_pk_bf16_f32 v6, v24, v25
v_lshlrev_b32 v24, 16, v6
v_and_b32 v25, s14, v6
v_cvt_pk_bf16_f32 v6, v26, v27
v_lshlrev_b32 v26, 16, v6
v_and_b32 v27, s14, v6
v_mul_f32 v26, 0x3d93cd3a, v26
v_mul_f32 v27, 0x3d93cd3a, v27
v_cvt_pk_bf16_f32 v6, v26, v27
v_lshlrev_b32 v26, 16, v6
v_and_b32 v27, s14, v6
v_max3_f32 v6, v24, v25, v26
v_max_f32 v6, v6, v27
s_nop 1
v_max_f32_dpp v6, v6, v6 quad_perm:[1,0,3,2] row_mask:0xf bank_mask:0xf
s_nop 1
v_max_f32_dpp v6, v6, v6 quad_perm:[2,3,0,1] row_mask:0xf bank_mask:0xf
s_nop 1
v_max_f32_dpp v6, v6, v6 row_half_mirror row_mask:0xf bank_mask:0xf
s_nop 1
v_max_f32_dpp v6, v6, v6 row_mirror row_mask:0xf bank_mask:0xf
s_nop 1
v_max_f32_dpp v6, v6, v6 row_bcast:15 row_mask:0xa bank_mask:0xf
s_nop 1
v_max_f32_dpp v6, v6, v6 row_bcast:31 row_mask:0xc bank_mask:0xf
s_nop 0
v_readlane_b32 s20, v6, 63
v_mov_b32 v7, 0x3fb8aa3b
s_nop 0
v_mul_f32 v6, s20, v7
v_fma_f32 v24, v24, v7, -v6
v_fma_f32 v25, v25, v7, -v6
v_fma_f32 v26, v26, v7, -v6
v_fma_f32 v27, v27, v7, -v6
v_exp_f32 v24, v24
v_exp_f32 v25, v25
v_exp_f32 v26, v26
v_exp_f32 v27, v27
v_bfrev_b32 v4, v0
v_lshrrev_b32 v4, 27, v4
v_lshlrev_b32 v4, 1, v4
v_lshrrev_b32 v11, 5, v0
v_lshlrev_b32 v11, 8, v11
s_lshl_b32 s13, s3, 9
v_add_u32 v11, s13, v11
v_add_u32 v4, v4, v11
v_cvt_pk_bf16_f32 v8, v24, v25
v_cvt_pk_bf16_f32 v9, v26, v27
ds_write_b16 v4, v8 offset:17408
ds_write_b16_d16_hi v4, v8 offset:17472
ds_write_b16 v4, v9 offset:17536
ds_write_b16_d16_hi v4, v9 offset:17600
v_add_f32 v6, v24, v25
v_add_f32 v7, v26, v27
v_add_f32 v6, v6, v7
s_nop 1
v_add_f32_dpp v6, v6, v6 quad_perm:[1,0,3,2] row_mask:0xf bank_mask:0xf
s_nop 1
v_add_f32_dpp v6, v6, v6 quad_perm:[2,3,0,1] row_mask:0xf bank_mask:0xf
s_nop 1
v_add_f32_dpp v6, v6, v6 row_half_mirror row_mask:0xf bank_mask:0xf
s_nop 1
v_add_f32_dpp v6, v6, v6 row_mirror row_mask:0xf bank_mask:0xf
s_nop 1
v_add_f32_dpp v6, v6, v6 row_bcast:15 row_mask:0xa bank_mask:0xf
s_nop 1
v_add_f32_dpp v6, v6, v6 row_bcast:31 row_mask:0xc bank_mask:0xf
s_nop 0
v_readlane_b32 s21, v6, 63
v_mov_b32 v20, s20
s_nop 0
v_mov_b32 v21, s21
s_lshl_b32 s13, s3, 3
v_mov_b32 v22, s13
s_mov_b64 exec, 1
ds_write_b64 v22, v[20:21] offset:16384
s_mov_b64 exec, -1
s_waitcnt lgkmcnt(0)
ds_read_b128 v[4:7], v11 offset:17408
ds_read_b128 v[24:27], v11 offset:17424
v_mov_b32 v219, 0
v_mov_b32 v223, 0
v_mov_b32 v227, 0
v_mov_b32 v231, 0
v_mov_b32 v235, 0
v_mov_b32 v239, 0
s_waitcnt vmcnt(8)
v_perm_b32 v195, v228, v224, s96
v_perm_b32 v199, v228, v224, s97
v_perm_b32 v203, v229, v225, s96
v_perm_b32 v207, v229, v225, s97
v_perm_b32 v211, v230, v226, s96
v_perm_b32 v215, v230, v226, s97
buffer_load_dwordx3 v[224:226], v1, s[44:47], s18 offen nt
s_add_u32 s18, s18, 12288
s_cmp_eq_u32 s18, 1572864
s_cselect_b32 s18, 0, s18
buffer_load_dwordx3 v[228:230], v1, s[44:47], s18 offen nt
s_add_u32 s18, s18, 12288
s_cmp_eq_u32 s18, 1572864
s_cselect_b32 s18, 0, s18
s_waitcnt lgkmcnt(1)
v_dot2c_f32_bf16 v219, v195, v4
v_dot2c_f32_bf16 v223, v199, v4
v_dot2c_f32_bf16 v227, v203, v4
v_dot2c_f32_bf16 v231, v207, v4
v_dot2c_f32_bf16 v235, v211, v4
v_dot2c_f32_bf16 v239, v215, v4
v_perm_b32 v67, v204, v200, s97
v_perm_b32 v75, v205, v201, s96
v_perm_b32 v83, v205, v201, s97
v_perm_b32 v99, v204, v200, s96
v_perm_b32 v201, v206, v202, s97
v_perm_b32 v91, v206, v202, s96
v_cndmask_b32_e64 v99, v99, v201, s[100:101]
s_mov_b32 s19, 29440
buffer_load_dwordx3 v[220:222], v2, s[52:55], s19 offen
s_waitcnt vmcnt(9)
v_perm_b32 v195, v236, v232, s96
v_perm_b32 v199, v236, v232, s97
v_perm_b32 v203, v237, v233, s96
v_perm_b32 v207, v237, v233, s97
v_perm_b32 v211, v238, v234, s96
v_perm_b32 v215, v238, v234, s97
buffer_load_dwordx3 v[232:234], v1, s[44:47], s18 offen nt
s_add_u32 s18, s18, 12288
s_cmp_eq_u32 s18, 1572864
s_cselect_b32 s18, 0, s18
buffer_load_dwordx3 v[236:238], v1, s[44:47], s18 offen nt
s_add_u32 s18, s18, 12288
s_cmp_eq_u32 s18, 1572864
s_cselect_b32 s18, 0, s18
v_dot2c_f32_bf16 v219, v195, v5
v_dot2c_f32_bf16 v223, v199, v5
v_dot2c_f32_bf16 v227, v203, v5
v_dot2c_f32_bf16 v231, v207, v5
v_dot2c_f32_bf16 v235, v211, v5
v_dot2c_f32_bf16 v239, v215, v5
s_waitcnt vmcnt(8)
v_perm_b32 v195, v244, v240, s96
v_perm_b32 v199, v244, v240, s97
v_perm_b32 v203, v245, v241, s96
v_perm_b32 v207, v245, v241, s97
v_perm_b32 v211, v246, v242, s96
v_perm_b32 v215, v246, v242, s97
buffer_load_dwordx3 v[240:242], v1, s[44:47], s18 offen nt
s_add_u32 s18, s18, 12288
s_cmp_eq_u32 s18, 1572864
s_cselect_b32 s18, 0, s18
buffer_load_dwordx3 v[244:246], v1, s[44:47], s18 offen nt
s_add_u32 s18, s18, 12288
s_cmp_eq_u32 s18, 1572864
s_cselect_b32 s18, 0, s18
v_dot2c_f32_bf16 v219, v195, v6
v_dot2c_f32_bf16 v223, v199, v6
v_dot2c_f32_bf16 v227, v203, v6
v_dot2c_f32_bf16 v231, v207, v6
v_dot2c_f32_bf16 v235, v211, v6
v_dot2c_f32_bf16 v239, v215, v6
s_mov_b32 s19, 30720
buffer_load_dwordx3 v[192:194], v2, s[52:55], s19 offen
s_waitcnt vmcnt(8)
v_perm_b32 v195, v252, v248, s96
v_perm_b32 v199, v252, v248, s97
v_perm_b32 v203, v253, v249, s96
v_perm_b32 v207, v253, v249, s97
v_perm_b32 v211, v254, v250, s96
v_perm_b32 v215, v254, v250, s97
buffer_load_dwordx3 v[248:250], v1, s[44:47], s18 offen nt
s_add_u32 s18, s18, 12288
s_cmp_eq_u32 s18, 1572864
s_cselect_b32 s18, 0, s18
buffer_load_dwordx3 v[252:254], v1, s[44:47], s18 offen nt
s_add_u32 s18, s18, 12288
s_cmp_eq_u32 s18, 1572864
s_cselect_b32 s18, 0, s18
v_dot2c_f32_bf16 v219, v195, v7
v_dot2c_f32_bf16 v223, v199, v7
v_dot2c_f32_bf16 v227, v203, v7
v_dot2c_f32_bf16 v231, v207, v7
v_dot2c_f32_bf16 v235, v211, v7
v_dot2c_f32_bf16 v239, v215, v7
ds_read_b128 v[4:7], v11 offset:17440
v_perm_b32 v107, v212, v208, s97
v_perm_b32 v115, v213, v209, s96
v_perm_b32 v123, v213, v209, s97
v_perm_b32 v139, v212, v208, s96
v_perm_b32 v209, v214, v210, s97
v_perm_b32 v131, v214, v210, s96
v_cndmask_b32_e64 v139, v139, v209, s[100:101]
s_mov_b32 s19, 32000
buffer_load_dwordx3 v[196:198], v2, s[52:55], s19 offen
s_waitcnt vmcnt(9)
v_perm_b32 v195, v228, v224, s96
v_perm_b32 v199, v228, v224, s97
v_perm_b32 v203, v229, v225, s96
v_perm_b32 v207, v229, v225, s97
v_perm_b32 v211, v230, v226, s96
v_perm_b32 v215, v230, v226, s97
buffer_load_dwordx3 v[224:226], v1, s[44:47], s18 offen nt
s_add_u32 s18, s18, 12288
s_cmp_eq_u32 s18, 1572864
s_cselect_b32 s18, 0, s18
buffer_load_dwordx3 v[228:230], v1, s[44:47], s18 offen nt
s_add_u32 s18, s18, 12288
s_cmp_eq_u32 s18, 1572864
s_cselect_b32 s18, 0, s18
s_waitcnt lgkmcnt(1)
v_dot2c_f32_bf16 v219, v195, v24
v_dot2c_f32_bf16 v223, v199, v24
v_dot2c_f32_bf16 v227, v203, v24
v_dot2c_f32_bf16 v231, v207, v24
v_dot2c_f32_bf16 v235, v211, v24
v_dot2c_f32_bf16 v239, v215, v24
s_waitcnt vmcnt(8)
v_perm_b32 v195, v236, v232, s96
v_perm_b32 v199, v236, v232, s97
v_perm_b32 v203, v237, v233, s96
v_perm_b32 v207, v237, v233, s97
v_perm_b32 v211, v238, v234, s96
v_perm_b32 v215, v238, v234, s97
buffer_load_dwordx3 v[232:234], v1, s[44:47], s18 offen nt
s_add_u32 s18, s18, 12288
s_cmp_eq_u32 s18, 1572864
s_cselect_b32 s18, 0, s18
buffer_load_dwordx3 v[236:238], v1, s[44:47], s18 offen nt
s_add_u32 s18, s18, 12288
s_cmp_eq_u32 s18, 1572864
s_cselect_b32 s18, 0, s18
v_dot2c_f32_bf16 v219, v195, v25
v_dot2c_f32_bf16 v223, v199, v25
v_dot2c_f32_bf16 v227, v203, v25
v_dot2c_f32_bf16 v231, v207, v25
v_dot2c_f32_bf16 v235, v211, v25
v_dot2c_f32_bf16 v239, v215, v25
s_mov_b32 s19, 34560
buffer_load_dwordx3 v[200:202], v2, s[52:55], s19 offen
s_waitcnt vmcnt(9)
v_perm_b32 v195, v244, v240, s96
v_perm_b32 v199, v244, v240, s97
v_perm_b32 v203, v245, v241, s96
v_perm_b32 v207, v245, v241, s97
v_perm_b32 v211, v246, v242, s96
v_perm_b32 v215, v246, v242, s97
buffer_load_dwordx3 v[240:242], v1, s[44:47], s18 offen nt
s_add_u32 s18, s18, 12288
s_cmp_eq_u32 s18, 1572864
s_cselect_b32 s18, 0, s18
buffer_load_dwordx3 v[244:246], v1, s[44:47], s18 offen nt
s_add_u32 s18, s18, 12288
s_cmp_eq_u32 s18, 1572864
s_cselect_b32 s18, 0, s18
v_dot2c_f32_bf16 v219, v195, v26
v_dot2c_f32_bf16 v223, v199, v26
v_dot2c_f32_bf16 v227, v203, v26
v_dot2c_f32_bf16 v231, v207, v26
v_dot2c_f32_bf16 v235, v211, v26
v_dot2c_f32_bf16 v239, v215, v26
v_perm_b32 v147, v220, v216, s97
v_perm_b32 v155, v221, v217, s96
v_perm_b32 v163, v221, v217, s97
v_perm_b32 v179, v220, v216, s96
v_perm_b32 v217, v222, v218, s97
v_perm_b32 v171, v222, v218, s96
v_cndmask_b32_e64 v179, v179, v217, s[100:101]
s_mov_b32 s19, 35840
buffer_load_dwordx3 v[204:206], v2, s[52:55], s19 offen
s_waitcnt vmcnt(9)
v_perm_b32 v195, v252, v248, s96
v_perm_b32 v199, v252, v248, s97
v_perm_b32 v203, v253, v249, s96
v_perm_b32 v207, v253, v249, s97
v_perm_b32 v211, v254, v250, s96
v_perm_b32 v215, v254, v250, s97
buffer_load_dwordx3 v[248:250], v1, s[44:47], s18 offen nt
s_add_u32 s18, s18, 12288
s_cmp_eq_u32 s18, 1572864
s_cselect_b32 s18, 0, s18
buffer_load_dwordx3 v[252:254], v1, s[44:47], s18 offen nt
s_add_u32 s18, s18, 12288
s_cmp_eq_u32 s18, 1572864
s_cselect_b32 s18, 0, s18
v_dot2c_f32_bf16 v219, v195, v27
v_dot2c_f32_bf16 v223, v199, v27
v_dot2c_f32_bf16 v227, v203, v27
v_dot2c_f32_bf16 v231, v207, v27
v_dot2c_f32_bf16 v235, v211, v27
v_dot2c_f32_bf16 v239, v215, v27
ds_read_b128 v[24:27], v11 offset:17456
s_barrier
s_waitcnt vmcnt(8)
v_perm_b32 v195, v228, v224, s96
v_perm_b32 v199, v228, v224, s97
v_perm_b32 v203, v229, v225, s96
v_perm_b32 v207, v229, v225, s97
v_perm_b32 v211, v230, v226, s96
v_perm_b32 v215, v230, v226, s97
buffer_load_dwordx3 v[224:226], v1, s[44:47], s18 offen nt
s_add_u32 s18, s18, 12288
s_cmp_eq_u32 s18, 1572864
s_cselect_b32 s18, 0, s18
buffer_load_dwordx3 v[228:230], v1, s[44:47], s18 offen nt
s_add_u32 s18, s18, 12288
s_cmp_eq_u32 s18, 1572864
s_cselect_b32 s18, 0, s18
s_waitcnt lgkmcnt(1)
v_dot2c_f32_bf16 v219, v195, v4
v_dot2c_f32_bf16 v223, v199, v4
v_dot2c_f32_bf16 v227, v203, v4
v_dot2c_f32_bf16 v231, v207, v4
v_dot2c_f32_bf16 v235, v211, v4
v_dot2c_f32_bf16 v239, v215, v4
s_mov_b32 s19, 33280
buffer_load_dwordx3 v[208:210], v2, s[52:55], s19 offen
v_and_b32 v22, 7, v0
v_lshlrev_b32 v22, 3, v22
ds_read_b64 v[20:21], v22 offset:16384
s_waitcnt vmcnt(9)
v_perm_b32 v195, v236, v232, s96
v_perm_b32 v199, v236, v232, s97
v_perm_b32 v203, v237, v233, s96
v_perm_b32 v207, v237, v233, s97
v_perm_b32 v211, v238, v234, s96
v_perm_b32 v215, v238, v234, s97
buffer_load_dwordx3 v[232:234], v1, s[44:47], s18 offen nt
s_add_u32 s18, s18, 12288
s_cmp_eq_u32 s18, 1572864
s_cselect_b32 s18, 0, s18
buffer_load_dwordx3 v[236:238], v1, s[44:47], s18 offen nt
s_add_u32 s18, s18, 12288
s_cmp_eq_u32 s18, 1572864
s_cselect_b32 s18, 0, s18
v_dot2c_f32_bf16 v219, v195, v5
v_dot2c_f32_bf16 v223, v199, v5
v_dot2c_f32_bf16 v227, v203, v5
v_dot2c_f32_bf16 v231, v207, v5
v_dot2c_f32_bf16 v235, v211, v5
v_dot2c_f32_bf16 v239, v215, v5
v_perm_b32 v68, v196, v192, s97
v_perm_b32 v76, v197, v193, s96
v_perm_b32 v84, v197, v193, s97
v_perm_b32 v100, v196, v192, s96
v_perm_b32 v193, v198, v194, s97
v_perm_b32 v92, v198, v194, s96
v_cndmask_b32_e64 v100, v100, v193, s[100:101]
s_lshl_b32 s13, s3, 1
s_add_u32 s13, s13, s6
s_lshl_b32 s13, s13, 6
v_lshl_add_u32 v22, v0, 3, s13
s_waitcnt lgkmcnt(0)
s_mov_b64 exec, 0xff
buffer_store_dwordx2 v[20:21], v22, s[80:83], 0 offen sc1
s_mov_b64 exec, -1
s_mov_b32 s19, 37120
buffer_load_dwordx3 v[212:214], v2, s[52:55], s19 offen
s_waitcnt vmcnt(10)
v_perm_b32 v195, v244, v240, s96
v_perm_b32 v199, v244, v240, s97
v_perm_b32 v203, v245, v241, s96
v_perm_b32 v207, v245, v241, s97
v_perm_b32 v211, v246, v242, s96
v_perm_b32 v215, v246, v242, s97
buffer_load_dwordx3 v[240:242], v1, s[44:47], s18 offen nt
s_add_u32 s18, s18, 12288
s_cmp_eq_u32 s18, 1572864
s_cselect_b32 s18, 0, s18
buffer_load_dwordx3 v[244:246], v1, s[44:47], s18 offen nt
s_add_u32 s18, s18, 12288
s_cmp_eq_u32 s18, 1572864
s_cselect_b32 s18, 0, s18
v_dot2c_f32_bf16 v219, v195, v6
v_dot2c_f32_bf16 v223, v199, v6
v_dot2c_f32_bf16 v227, v203, v6
v_dot2c_f32_bf16 v231, v207, v6
v_dot2c_f32_bf16 v235, v211, v6
v_dot2c_f32_bf16 v239, v215, v6
s_waitcnt vmcnt(9)
v_perm_b32 v195, v252, v248, s96
v_perm_b32 v199, v252, v248, s97
v_perm_b32 v203, v253, v249, s96
v_perm_b32 v207, v253, v249, s97
v_perm_b32 v211, v254, v250, s96
v_perm_b32 v215, v254, v250, s97
buffer_load_dwordx3 v[248:250], v1, s[44:47], s18 offen nt
s_add_u32 s18, s18, 12288
s_cmp_eq_u32 s18, 1572864
s_cselect_b32 s18, 0, s18
buffer_load_dwordx3 v[252:254], v1, s[44:47], s18 offen nt
s_add_u32 s18, s18, 12288
s_cmp_eq_u32 s18, 1572864
s_cselect_b32 s18, 0, s18
v_dot2c_f32_bf16 v219, v195, v7
v_dot2c_f32_bf16 v223, v199, v7
v_dot2c_f32_bf16 v227, v203, v7
v_dot2c_f32_bf16 v231, v207, v7
v_dot2c_f32_bf16 v235, v211, v7
v_dot2c_f32_bf16 v239, v215, v7
ds_read_b128 v[4:7], v11 offset:17472
s_mov_b32 s19, 38400
buffer_load_dwordx3 v[216:218], v2, s[52:55], s19 offen
s_lshl_b32 s13, s3, 8
v_lshl_add_u32 v28, v0, 2, s13
buffer_load_dword v28, v28, s[84:87], 0 offen sc1
s_waitcnt vmcnt(11)
v_perm_b32 v195, v228, v224, s96
v_perm_b32 v199, v228, v224, s97
v_perm_b32 v203, v229, v225, s96
v_perm_b32 v207, v229, v225, s97
v_perm_b32 v211, v230, v226, s96
v_perm_b32 v215, v230, v226, s97
buffer_load_dwordx3 v[224:226], v1, s[44:47], s18 offen nt
s_add_u32 s18, s18, 12288
s_cmp_eq_u32 s18, 1572864
s_cselect_b32 s18, 0, s18
buffer_load_dwordx3 v[228:230], v1, s[44:47], s18 offen nt
s_add_u32 s18, s18, 12288
s_cmp_eq_u32 s18, 1572864
s_cselect_b32 s18, 0, s18
v_dot2c_f32_bf16 v219, v195, v24
v_dot2c_f32_bf16 v223, v199, v24
v_dot2c_f32_bf16 v227, v203, v24
v_dot2c_f32_bf16 v231, v207, v24
v_dot2c_f32_bf16 v235, v211, v24
v_dot2c_f32_bf16 v239, v215, v24
v_perm_b32 v108, v204, v200, s97
v_perm_b32 v116, v205, v201, s96
v_perm_b32 v124, v205, v201, s97
v_perm_b32 v140, v204, v200, s96
v_perm_b32 v201, v206, v202, s97
v_perm_b32 v132, v206, v202, s96
v_cndmask_b32_e64 v140, v140, v201, s[100:101]
s_mov_b32 s19, 39680
buffer_load_dwordx3 v[220:222], v2, s[52:55], s19 offen
s_waitcnt vmcnt(11)
v_perm_b32 v195, v236, v232, s96
v_perm_b32 v199, v236, v232, s97
v_perm_b32 v203, v237, v233, s96
v_perm_b32 v207, v237, v233, s97
v_perm_b32 v211, v238, v234, s96
v_perm_b32 v215, v238, v234, s97
buffer_load_dwordx3 v[232:234], v1, s[44:47], s18 offen nt
s_add_u32 s18, s18, 12288
s_cmp_eq_u32 s18, 1572864
s_cselect_b32 s18, 0, s18
buffer_load_dwordx3 v[236:238], v1, s[44:47], s18 offen nt
s_add_u32 s18, s18, 12288
s_cmp_eq_u32 s18, 1572864
s_cselect_b32 s18, 0, s18
v_dot2c_f32_bf16 v219, v195, v25
v_dot2c_f32_bf16 v223, v199, v25
v_dot2c_f32_bf16 v227, v203, v25
v_dot2c_f32_bf16 v231, v207, v25
v_dot2c_f32_bf16 v235, v211, v25
v_dot2c_f32_bf16 v239, v215, v25
s_waitcnt vmcnt(9)
v_perm_b32 v195, v244, v240, s96
v_perm_b32 v199, v244, v240, s97
v_perm_b32 v203, v245, v241, s96
v_perm_b32 v207, v245, v241, s97
v_perm_b32 v211, v246, v242, s96
v_perm_b32 v215, v246, v242, s97
buffer_load_dwordx3 v[240:242], v1, s[44:47], s18 offen nt
s_add_u32 s18, s18, 12288
s_cmp_eq_u32 s18, 1572864
s_cselect_b32 s18, 0, s18
buffer_load_dwordx3 v[244:246], v1, s[44:47], s18 offen nt
s_add_u32 s18, s18, 12288
s_cmp_eq_u32 s18, 1572864
s_cselect_b32 s18, 0, s18
v_dot2c_f32_bf16 v219, v195, v26
v_dot2c_f32_bf16 v223, v199, v26
v_dot2c_f32_bf16 v227, v203, v26
v_dot2c_f32_bf16 v231, v207, v26
v_dot2c_f32_bf16 v235, v211, v26
v_dot2c_f32_bf16 v239, v215, v26
s_mov_b32 s19, 42240
buffer_load_dwordx3 v[192:194], v2, s[52:55], s19 offen
s_waitcnt vmcnt(10)
v_perm_b32 v195, v252, v248, s96
v_perm_b32 v199, v252, v248, s97
v_perm_b32 v203, v253, v249, s96
v_perm_b32 v207, v253, v249, s97
v_perm_b32 v211, v254, v250, s96
v_perm_b32 v215, v254, v250, s97
buffer_load_dwordx3 v[248:250], v1, s[44:47], s18 offen nt
s_add_u32 s18, s18, 12288
s_cmp_eq_u32 s18, 1572864
s_cselect_b32 s18, 0, s18
buffer_load_dwordx3 v[252:254], v1, s[44:47], s18 offen nt
s_add_u32 s18, s18, 12288
s_cmp_eq_u32 s18, 1572864
s_cselect_b32 s18, 0, s18
v_dot2c_f32_bf16 v219, v195, v27
v_dot2c_f32_bf16 v223, v199, v27
v_dot2c_f32_bf16 v227, v203, v27
v_dot2c_f32_bf16 v231, v207, v27
v_dot2c_f32_bf16 v235, v211, v27
v_dot2c_f32_bf16 v239, v215, v27
ds_read_b128 v[24:27], v11 offset:17488
v_perm_b32 v148, v212, v208, s97
v_perm_b32 v156, v213, v209, s96
v_perm_b32 v164, v213, v209, s97
v_perm_b32 v180, v212, v208, s96
v_perm_b32 v209, v214, v210, s97
v_perm_b32 v172, v214, v210, s96
v_cndmask_b32_e64 v180, v180, v209, s[100:101]
s_mov_b32 s19, 43520
buffer_load_dwordx3 v[196:198], v2, s[52:55], s19 offen
s_barrier
s_waitcnt vmcnt(9)
v_perm_b32 v195, v228, v224, s96
v_perm_b32 v199, v228, v224, s97
v_perm_b32 v203, v229, v225, s96
v_perm_b32 v207, v229, v225, s97
v_perm_b32 v211, v230, v226, s96
v_perm_b32 v215, v230, v226, s97
buffer_load_dwordx3 v[224:226], v1, s[44:47], s18 offen nt
s_add_u32 s18, s18, 12288
s_cmp_eq_u32 s18, 1572864
s_cselect_b32 s18, 0, s18
buffer_load_dwordx3 v[228:230], v1, s[44:47], s18 offen nt
s_add_u32 s18, s18, 12288
s_cmp_eq_u32 s18, 1572864
s_cselect_b32 s18, 0, s18
s_waitcnt lgkmcnt(1)
v_dot2c_f32_bf16 v219, v195, v4
v_dot2c_f32_bf16 v223, v199, v4
v_dot2c_f32_bf16 v227, v203, v4
v_dot2c_f32_bf16 v231, v207, v4
v_dot2c_f32_bf16 v235, v211, v4
v_dot2c_f32_bf16 v239, v215, v4
s_waitcnt vmcnt(8)
v_perm_b32 v195, v236, v232, s96
v_perm_b32 v199, v236, v232, s97
v_perm_b32 v203, v237, v233, s96
v_perm_b32 v207, v237, v233, s97
v_perm_b32 v211, v238, v234, s96
v_perm_b32 v215, v238, v234, s97
buffer_load_dwordx3 v[232:234], v1, s[44:47], s18 offen nt
s_add_u32 s18, s18, 12288
s_cmp_eq_u32 s18, 1572864
s_cselect_b32 s18, 0, s18
buffer_load_dwordx3 v[236:238], v1, s[44:47], s18 offen nt
s_add_u32 s18, s18, 12288
s_cmp_eq_u32 s18, 1572864
s_cselect_b32 s18, 0, s18
v_dot2c_f32_bf16 v219, v195, v5
v_dot2c_f32_bf16 v223, v199, v5
v_dot2c_f32_bf16 v227, v203, v5
v_dot2c_f32_bf16 v231, v207, v5
v_dot2c_f32_bf16 v235, v211, v5
v_dot2c_f32_bf16 v239, v215, v5
s_mov_b32 s19, 40960
buffer_load_dwordx3 v[200:202], v2, s[52:55], s19 offen
s_waitcnt vmcnt(9)
v_perm_b32 v195, v244, v240, s96
v_perm_b32 v199, v244, v240, s97
v_perm_b32 v203, v245, v241, s96
v_perm_b32 v207, v245, v241, s97
v_perm_b32 v211, v246, v242, s96
v_perm_b32 v215, v246, v242, s97
buffer_load_dwordx3 v[240:242], v1, s[44:47], s18 offen nt
s_add_u32 s18, s18, 12288
s_cmp_eq_u32 s18, 1572864
s_cselect_b32 s18, 0, s18
buffer_load_dwordx3 v[244:246], v1, s[44:47], s18 offen nt
s_add_u32 s18, s18, 12288
s_cmp_eq_u32 s18, 1572864
s_cselect_b32 s18, 0, s18
v_dot2c_f32_bf16 v219, v195, v6
v_dot2c_f32_bf16 v223, v199, v6
v_dot2c_f32_bf16 v227, v203, v6
v_dot2c_f32_bf16 v231, v207, v6
v_dot2c_f32_bf16 v235, v211, v6
v_dot2c_f32_bf16 v239, v215, v6
v_perm_b32 v69, v220, v216, s97
v_perm_b32 v77, v221, v217, s96
v_perm_b32 v85, v221, v217, s97
v_perm_b32 v101, v220, v216, s96
v_perm_b32 v217, v222, v218, s97
v_perm_b32 v93, v222, v218, s96
v_cndmask_b32_e64 v101, v101, v217, s[100:101]
s_mov_b32 s19, 44800
buffer_load_dwordx3 v[204:206], v2, s[52:55], s19 offen
s_waitcnt vmcnt(9)
v_perm_b32 v195, v252, v248, s96
v_perm_b32 v199, v252, v248, s97
v_perm_b32 v203, v253, v249, s96
v_perm_b32 v207, v253, v249, s97
v_perm_b32 v211, v254, v250, s96
v_perm_b32 v215, v254, v250, s97
buffer_load_dwordx3 v[248:250], v1, s[44:47], s18 offen nt
s_add_u32 s18, s18, 12288
s_cmp_eq_u32 s18, 1572864
s_cselect_b32 s18, 0, s18
buffer_load_dwordx3 v[252:254], v1, s[44:47], s18 offen nt
s_add_u32 s18, s18, 12288
s_cmp_eq_u32 s18, 1572864
s_cselect_b32 s18, 0, s18
v_dot2c_f32_bf16 v219, v195, v7
v_dot2c_f32_bf16 v223, v199, v7
v_dot2c_f32_bf16 v227, v203, v7
v_dot2c_f32_bf16 v231, v207, v7
v_dot2c_f32_bf16 v235, v211, v7
v_dot2c_f32_bf16 v239, v215, v7
ds_read_b128 v[4:7], v11 offset:17504
s_waitcnt vmcnt(8)
v_perm_b32 v195, v228, v224, s96
v_perm_b32 v199, v228, v224, s97
v_perm_b32 v203, v229, v225, s96
v_perm_b32 v207, v229, v225, s97
v_perm_b32 v211, v230, v226, s96
v_perm_b32 v215, v230, v226, s97
buffer_load_dwordx3 v[224:226], v1, s[44:47], s18 offen nt
s_add_u32 s18, s18, 12288
s_cmp_eq_u32 s18, 1572864
s_cselect_b32 s18, 0, s18
buffer_load_dwordx3 v[228:230], v1, s[44:47], s18 offen nt
s_add_u32 s18, s18, 12288
s_cmp_eq_u32 s18, 1572864
s_cselect_b32 s18, 0, s18
s_waitcnt lgkmcnt(1)
v_dot2c_f32_bf16 v219, v195, v24
v_dot2c_f32_bf16 v223, v199, v24
v_dot2c_f32_bf16 v227, v203, v24
v_dot2c_f32_bf16 v231, v207, v24
v_dot2c_f32_bf16 v235, v211, v24
v_dot2c_f32_bf16 v239, v215, v24
s_mov_b32 s19, 46080
buffer_load_dwordx3 v[208:210], v2, s[52:55], s19 offen
s_waitcnt vmcnt(9)
v_perm_b32 v195, v236, v232, s96
v_perm_b32 v199, v236, v232, s97
v_perm_b32 v203, v237, v233, s96
v_perm_b32 v207, v237, v233, s97
v_perm_b32 v211, v238, v234, s96
v_perm_b32 v215, v238, v234, s97
buffer_load_dwordx3 v[232:234], v1, s[44:47], s18 offen nt
s_add_u32 s18, s18, 12288
s_cmp_eq_u32 s18, 1572864
s_cselect_b32 s18, 0, s18
buffer_load_dwordx3 v[236:238], v1, s[44:47], s18 offen nt
s_add_u32 s18, s18, 12288
s_cmp_eq_u32 s18, 1572864
s_cselect_b32 s18, 0, s18
v_dot2c_f32_bf16 v219, v195, v25
v_dot2c_f32_bf16 v223, v199, v25
v_dot2c_f32_bf16 v227, v203, v25
v_dot2c_f32_bf16 v231, v207, v25
v_dot2c_f32_bf16 v235, v211, v25
v_dot2c_f32_bf16 v239, v215, v25
v_perm_b32 v109, v196, v192, s97
v_perm_b32 v117, v197, v193, s96
v_perm_b32 v125, v197, v193, s97
v_perm_b32 v141, v196, v192, s96
v_perm_b32 v193, v198, v194, s97
v_perm_b32 v133, v198, v194, s96
v_cndmask_b32_e64 v141, v141, v193, s[100:101]
s_mov_b32 s19, 47360
buffer_load_dwordx3 v[212:214], v2, s[52:55], s19 offen
s_waitcnt vmcnt(9)
v_perm_b32 v195, v244, v240, s96
v_perm_b32 v199, v244, v240, s97
v_perm_b32 v203, v245, v241, s96
v_perm_b32 v207, v245, v241, s97
v_perm_b32 v211, v246, v242, s96
v_perm_b32 v215, v246, v242, s97
buffer_load_dwordx3 v[240:242], v1, s[44:47], s18 offen nt
s_add_u32 s18, s18, 12288
s_cmp_eq_u32 s18, 1572864
s_cselect_b32 s18, 0, s18
buffer_load_dwordx3 v[244:246], v1, s[44:47], s18 offen nt
s_add_u32 s18, s18, 12288
s_cmp_eq_u32 s18, 1572864
s_cselect_b32 s18, 0, s18
v_dot2c_f32_bf16 v219, v195, v26
v_dot2c_f32_bf16 v223, v199, v26
v_dot2c_f32_bf16 v227, v203, v26
v_dot2c_f32_bf16 v231, v207, v26
v_dot2c_f32_bf16 v235, v211, v26
v_dot2c_f32_bf16 v239, v215, v26
s_waitcnt vmcnt(8)
v_perm_b32 v195, v252, v248, s96
v_perm_b32 v199, v252, v248, s97
v_perm_b32 v203, v253, v249, s96
v_perm_b32 v207, v253, v249, s97
v_perm_b32 v211, v254, v250, s96
v_perm_b32 v215, v254, v250, s97
buffer_load_dwordx3 v[248:250], v1, s[44:47], s18 offen nt
s_add_u32 s18, s18, 12288
s_cmp_eq_u32 s18, 1572864
s_cselect_b32 s18, 0, s18
buffer_load_dwordx3 v[252:254], v1, s[44:47], s18 offen nt
s_add_u32 s18, s18, 12288
s_cmp_eq_u32 s18, 1572864
s_cselect_b32 s18, 0, s18
v_dot2c_f32_bf16 v219, v195, v27
v_dot2c_f32_bf16 v223, v199, v27
v_dot2c_f32_bf16 v227, v203, v27
v_dot2c_f32_bf16 v231, v207, v27
v_dot2c_f32_bf16 v235, v211, v27
v_dot2c_f32_bf16 v239, v215, v27
ds_read_b128 v[24:27], v11 offset:17520
s_mov_b32 s19, 49920
buffer_load_dwordx3 v[216:218], v2, s[52:55], s19 offen
v_cmp_gt_u32 vcc, s31, v28
s_nop 4
s_cbranch_vccnz L_flag_slow
L_flag_ok:
s_barrier
s_waitcnt vmcnt(9)
v_perm_b32 v195, v228, v224, s96
v_perm_b32 v199, v228, v224, s97
v_perm_b32 v203, v229, v225, s96
v_perm_b32 v207, v229, v225, s97
v_perm_b32 v211, v230, v226, s96
v_perm_b32 v215, v230, v226, s97
buffer_load_dwordx3 v[224:226], v1, s[44:47], s18 offen nt
s_add_u32 s18, s18, 12288
s_cmp_eq_u32 s18, 1572864
s_cselect_b32 s18, 0, s18
buffer_load_dwordx3 v[228:230], v1, s[44:47], s18 offen nt
s_add_u32 s18, s18, 12288
s_cmp_eq_u32 s18, 1572864
s_cselect_b32 s18, 0, s18
s_waitcnt lgkmcnt(1)
v_dot2c_f32_bf16 v219, v195, v4
v_dot2c_f32_bf16 v223, v199, v4
v_dot2c_f32_bf16 v227, v203, v4
v_dot2c_f32_bf16 v231, v207, v4
v_dot2c_f32_bf16 v235, v211, v4
v_dot2c_f32_bf16 v239, v215, v4
v_perm_b32 v149, v204, v200, s97
v_perm_b32 v157, v205, v201, s96
v_perm_b32 v165, v205, v201, s97
v_perm_b32 v181, v204, v200, s96
v_perm_b32 v201, v206, v202, s97
v_perm_b32 v173, v206, v202, s96
v_cndmask_b32_e64 v181, v181, v201, s[100:101]
s_mov_b32 s19, 51200
buffer_load_dwordx3 v[220:222], v2, s[52:55], s19 offen
s_waitcnt vmcnt(9)
v_perm_b32 v195, v236, v232, s96
v_perm_b32 v199, v236, v232, s97
v_perm_b32 v203, v237, v233, s96
v_perm_b32 v207, v237, v233, s97
v_perm_b32 v211, v238, v234, s96
v_perm_b32 v215, v238, v234, s97
buffer_load_dwordx3 v[232:234], v1, s[44:47], s18 offen nt
s_add_u32 s18, s18, 12288
s_cmp_eq_u32 s18, 1572864
s_cselect_b32 s18, 0, s18
buffer_load_dwordx3 v[236:238], v1, s[44:47], s18 offen nt
s_add_u32 s18, s18, 12288
s_cmp_eq_u32 s18, 1572864
s_cselect_b32 s18, 0, s18
v_dot2c_f32_bf16 v219, v195, v5
v_dot2c_f32_bf16 v223, v199, v5
v_dot2c_f32_bf16 v227, v203, v5
v_dot2c_f32_bf16 v231, v207, v5
v_dot2c_f32_bf16 v235, v211, v5
v_dot2c_f32_bf16 v239, v215, v5
s_waitcnt vmcnt(8)
v_perm_b32 v195, v244, v240, s96
v_perm_b32 v199, v244, v240, s97
v_perm_b32 v203, v245, v241, s96
v_perm_b32 v207, v245, v241, s97
v_perm_b32 v211, v246, v242, s96
v_perm_b32 v215, v246, v242, s97
buffer_load_dwordx3 v[240:242], v1, s[44:47], s18 offen nt
s_add_u32 s18, s18, 12288
s_cmp_eq_u32 s18, 1572864
s_cselect_b32 s18, 0, s18
buffer_load_dwordx3 v[244:246], v1, s[44:47], s18 offen nt
s_add_u32 s18, s18, 12288
s_cmp_eq_u32 s18, 1572864
s_cselect_b32 s18, 0, s18
v_dot2c_f32_bf16 v219, v195, v6
v_dot2c_f32_bf16 v223, v199, v6
v_dot2c_f32_bf16 v227, v203, v6
v_dot2c_f32_bf16 v231, v207, v6
v_dot2c_f32_bf16 v235, v211, v6
v_dot2c_f32_bf16 v239, v215, v6
s_mov_b32 s19, 48640
buffer_load_dwordx3 v[192:194], v2, s[52:55], s19 offen
s_waitcnt vmcnt(9)
v_perm_b32 v195, v252, v248, s96
v_perm_b32 v199, v252, v248, s97
v_perm_b32 v203, v253, v249, s96
v_perm_b32 v207, v253, v249, s97
v_perm_b32 v211, v254, v250, s96
v_perm_b32 v215, v254, v250, s97
buffer_load_dwordx3 v[248:250], v1, s[44:47], s18 offen nt
s_add_u32 s18, s18, 12288
s_cmp_eq_u32 s18, 1572864
s_cselect_b32 s18, 0, s18
buffer_load_dwordx3 v[252:254], v1, s[44:47], s18 offen nt
s_add_u32 s18, s18, 12288
s_cmp_eq_u32 s18, 1572864
s_cselect_b32 s18, 0, s18
v_dot2c_f32_bf16 v219, v195, v7
v_dot2c_f32_bf16 v223, v199, v7
v_dot2c_f32_bf16 v227, v203, v7
v_dot2c_f32_bf16 v231, v207, v7
v_dot2c_f32_bf16 v235, v211, v7
v_dot2c_f32_bf16 v239, v215, v7
ds_read_b128 v[4:7], v11 offset:17536
v_perm_b32 v70, v212, v208, s97
v_perm_b32 v78, v213, v209, s96
v_perm_b32 v86, v213, v209, s97
v_perm_b32 v102, v212, v208, s96
v_perm_b32 v209, v214, v210, s97
v_perm_b32 v94, v214, v210, s96
v_cndmask_b32_e64 v102, v102, v209, s[100:101]
s_mov_b32 s19, 52480
buffer_load_dwordx3 v[196:198], v2, s[52:55], s19 offen
s_waitcnt vmcnt(9)
v_perm_b32 v195, v228, v224, s96
v_perm_b32 v199, v228, v224, s97
v_perm_b32 v203, v229, v225, s96
v_perm_b32 v207, v229, v225, s97
v_perm_b32 v211, v230, v226, s96
v_perm_b32 v215, v230, v226, s97
buffer_load_dwordx3 v[224:226], v1, s[44:47], s18 offen nt
s_add_u32 s18, s18, 12288
s_cmp_eq_u32 s18, 1572864
s_cselect_b32 s18, 0, s18
buffer_load_dwordx3 v[228:230], v1, s[44:47], s18 offen nt
s_add_u32 s18, s18, 12288
s_cmp_eq_u32 s18, 1572864
s_cselect_b32 s18, 0, s18
s_waitcnt lgkmcnt(1)
v_dot2c_f32_bf16 v219, v195, v24
v_dot2c_f32_bf16 v223, v199, v24
v_dot2c_f32_bf16 v227, v203, v24
v_dot2c_f32_bf16 v231, v207, v24
v_dot2c_f32_bf16 v235, v211, v24
v_dot2c_f32_bf16 v239, v215, v24
s_waitcnt vmcnt(8)
v_perm_b32 v195, v236, v232, s96
v_perm_b32 v199, v236, v232, s97
v_perm_b32 v203, v237, v233, s96
v_perm_b32 v207, v237, v233, s97
v_perm_b32 v211, v238, v234, s96
v_perm_b32 v215, v238, v234, s97
buffer_load_dwordx3 v[232:234], v1, s[44:47], s18 offen nt
s_add_u32 s18, s18, 12288
s_cmp_eq_u32 s18, 1572864
s_cselect_b32 s18, 0, s18
buffer_load_dwordx3 v[236:238], v1, s[44:47], s18 offen nt
s_add_u32 s18, s18, 12288
s_cmp_eq_u32 s18, 1572864
s_cselect_b32 s18, 0, s18
v_dot2c_f32_bf16 v219, v195, v25
v_dot2c_f32_bf16 v223, v199, v25
v_dot2c_f32_bf16 v227, v203, v25
v_dot2c_f32_bf16 v231, v207, v25
v_dot2c_f32_bf16 v235, v211, v25
v_dot2c_f32_bf16 v239, v215, v25
s_mov_b32 s19, 53760
buffer_load_dwordx3 v[200:202], v2, s[52:55], s19 offen
s_waitcnt vmcnt(9)
v_perm_b32 v195, v244, v240, s96
v_perm_b32 v199, v244, v240, s97
v_perm_b32 v203, v245, v241, s96
v_perm_b32 v207, v245, v241, s97
v_perm_b32 v211, v246, v242, s96
v_perm_b32 v215, v246, v242, s97
buffer_load_dwordx3 v[240:242], v1, s[44:47], s18 offen nt
s_add_u32 s18, s18, 12288
s_cmp_eq_u32 s18, 1572864
s_cselect_b32 s18, 0, s18
buffer_load_dwordx3 v[244:246], v1, s[44:47], s18 offen nt
s_add_u32 s18, s18, 12288
s_cmp_eq_u32 s18, 1572864
s_cselect_b32 s18, 0, s18
v_dot2c_f32_bf16 v219, v195, v26
v_dot2c_f32_bf16 v223, v199, v26
v_dot2c_f32_bf16 v227, v203, v26
v_dot2c_f32_bf16 v231, v207, v26
v_dot2c_f32_bf16 v235, v211, v26
v_dot2c_f32_bf16 v239, v215, v26
v_perm_b32 v110, v220, v216, s97
v_perm_b32 v118, v221, v217, s96
v_perm_b32 v126, v221, v217, s97
v_perm_b32 v142, v220, v216, s96
v_perm_b32 v217, v222, v218, s97
v_perm_b32 v134, v222, v218, s96
v_cndmask_b32_e64 v142, v142, v217, s[100:101]
s_mov_b32 s19, 55040
buffer_load_dwordx3 v[204:206], v2, s[52:55], s19 offen
v_lshlrev_b32 v8, 3, v0
buffer_load_dwordx2 v[8:9], v8, s[80:83], 0 offen sc1
s_waitcnt vmcnt(10)
v_perm_b32 v195, v252, v248, s96
v_perm_b32 v199, v252, v248, s97
v_perm_b32 v203, v253, v249, s96
v_perm_b32 v207, v253, v249, s97
v_perm_b32 v211, v254, v250, s96
v_perm_b32 v215, v254, v250, s97
buffer_load_dwordx3 v[248:250], v1, s[44:47], s18 offen nt
s_add_u32 s18, s18, 12288
s_cmp_eq_u32 s18, 1572864
s_cselect_b32 s18, 0, s18
buffer_load_dwordx3 v[252:254], v1, s[44:47], s18 offen nt
s_add_u32 s18, s18, 12288
s_cmp_eq_u32 s18, 1572864
s_cselect_b32 s18, 0, s18
v_dot2c_f32_bf16 v219, v195, v27
v_dot2c_f32_bf16 v223, v199, v27
v_dot2c_f32_bf16 v227, v203, v27
v_dot2c_f32_bf16 v231, v207, v27
v_dot2c_f32_bf16 v235, v211, v27
v_dot2c_f32_bf16 v239, v215, v27
ds_read_b128 v[24:27], v11 offset:17552
s_barrier
s_waitcnt vmcnt(9)
v_perm_b32 v195, v228, v224, s96
v_perm_b32 v199, v228, v224, s97
v_perm_b32 v203, v229, v225, s96
v_perm_b32 v207, v229, v225, s97
v_perm_b32 v211, v230, v226, s96
v_perm_b32 v215, v230, v226, s97
buffer_load_dwordx3 v[224:226], v1, s[44:47], s18 offen nt
s_add_u32 s18, s18, 12288
s_cmp_eq_u32 s18, 1572864
s_cselect_b32 s18, 0, s18
buffer_load_dwordx3 v[228:230], v1, s[44:47], s18 offen nt
s_add_u32 s18, s18, 12288
s_cmp_eq_u32 s18, 1572864
s_cselect_b32 s18, 0, s18
s_waitcnt lgkmcnt(1)
v_dot2c_f32_bf16 v219, v195, v4
v_dot2c_f32_bf16 v223, v199, v4
v_dot2c_f32_bf16 v227, v203, v4
v_dot2c_f32_bf16 v231, v207, v4
v_dot2c_f32_bf16 v235, v211, v4
v_dot2c_f32_bf16 v239, v215, v4
s_mov_b32 s19, 57600
buffer_load_dwordx3 v[208:210], v2, s[52:55], s19 offen
s_waitcnt vmcnt(10)
v_perm_b32 v195, v236, v232, s96
v_perm_b32 v199, v236, v232, s97
v_perm_b32 v203, v237, v233, s96
v_perm_b32 v207, v237, v233, s97
v_perm_b32 v211, v238, v234, s96
v_perm_b32 v215, v238, v234, s97
buffer_load_dwordx3 v[232:234], v1, s[44:47], s18 offen nt
s_add_u32 s18, s18, 12288
s_cmp_eq_u32 s18, 1572864
s_cselect_b32 s18, 0, s18
buffer_load_dwordx3 v[236:238], v1, s[44:47], s18 offen nt
s_add_u32 s18, s18, 12288
s_cmp_eq_u32 s18, 1572864
s_cselect_b32 s18, 0, s18
v_dot2c_f32_bf16 v219, v195, v5
v_dot2c_f32_bf16 v223, v199, v5
v_dot2c_f32_bf16 v227, v203, v5
v_dot2c_f32_bf16 v231, v207, v5
v_dot2c_f32_bf16 v235, v211, v5
v_dot2c_f32_bf16 v239, v215, v5
v_perm_b32 v150, v196, v192, s97
v_perm_b32 v158, v197, v193, s96
v_perm_b32 v166, v197, v193, s97
v_perm_b32 v182, v196, v192, s96
v_perm_b32 v193, v198, v194, s97
v_perm_b32 v174, v198, v194, s96
v_cndmask_b32_e64 v182, v182, v193, s[100:101]
s_mov_b32 s19, 58880
buffer_load_dwordx3 v[212:214], v2, s[52:55], s19 offen
s_waitcnt vmcnt(10)
v_perm_b32 v195, v244, v240, s96
v_perm_b32 v199, v244, v240, s97
v_perm_b32 v203, v245, v241, s96
v_perm_b32 v207, v245, v241, s97
v_perm_b32 v211, v246, v242, s96
v_perm_b32 v215, v246, v242, s97
buffer_load_dwordx3 v[240:242], v1, s[44:47], s18 offen nt
s_add_u32 s18, s18, 12288
s_cmp_eq_u32 s18, 1572864
s_cselect_b32 s18, 0, s18
buffer_load_dwordx3 v[244:246], v1, s[44:47], s18 offen nt
s_add_u32 s18, s18, 12288
s_cmp_eq_u32 s18, 1572864
s_cselect_b32 s18, 0, s18
v_dot2c_f32_bf16 v219, v195, v6
v_dot2c_f32_bf16 v223, v199, v6
v_dot2c_f32_bf16 v227, v203, v6
v_dot2c_f32_bf16 v231, v207, v6
v_dot2c_f32_bf16 v235, v211, v6
v_dot2c_f32_bf16 v239, v215, v6
s_waitcnt vmcnt(8)
v_perm_b32 v195, v252, v248, s96
v_perm_b32 v199, v252, v248, s97
v_perm_b32 v203, v253, v249, s96
v_perm_b32 v207, v253, v249, s97
v_perm_b32 v211, v254, v250, s96
v_perm_b32 v215, v254, v250, s97
buffer_load_dwordx3 v[248:250], v1, s[44:47], s18 offen nt
s_add_u32 s18, s18, 12288
s_cmp_eq_u32 s18, 1572864
s_cselect_b32 s18, 0, s18
buffer_load_dwordx3 v[252:254], v1, s[44:47], s18 offen nt
s_add_u32 s18, s18, 12288
s_cmp_eq_u32 s18, 1572864
s_cselect_b32 s18, 0, s18
v_dot2c_f32_bf16 v219, v195, v7
v_dot2c_f32_bf16 v223, v199, v7
v_dot2c_f32_bf16 v227, v203, v7
v_dot2c_f32_bf16 v231, v207, v7
v_dot2c_f32_bf16 v235, v211, v7
v_dot2c_f32_bf16 v239, v215, v7
ds_read_b128 v[4:7], v11 offset:17568
s_mov_b32 s19, 56320
buffer_load_dwordx3 v[216:218], v2, s[52:55], s19 offen
s_waitcnt vmcnt(9)
v_perm_b32 v195, v228, v224, s96
v_perm_b32 v199, v228, v224, s97
v_perm_b32 v203, v229, v225, s96
v_perm_b32 v207, v229, v225, s97
v_perm_b32 v211, v230, v226, s96
v_perm_b32 v215, v230, v226, s97
buffer_load_dwordx3 v[224:226], v1, s[44:47], s18 offen nt
s_add_u32 s18, s18, 12288
s_cmp_eq_u32 s18, 1572864
s_cselect_b32 s18, 0, s18
buffer_load_dwordx3 v[228:230], v1, s[44:47], s18 offen nt
s_add_u32 s18, s18, 12288
s_cmp_eq_u32 s18, 1572864
s_cselect_b32 s18, 0, s18
s_waitcnt lgkmcnt(1)
v_dot2c_f32_bf16 v219, v195, v24
v_dot2c_f32_bf16 v223, v199, v24
v_dot2c_f32_bf16 v227, v203, v24
v_dot2c_f32_bf16 v231, v207, v24
v_dot2c_f32_bf16 v235, v211, v24
v_dot2c_f32_bf16 v239, v215, v24
v_perm_b32 v71, v204, v200, s97
v_perm_b32 v79, v205, v201, s96
v_perm_b32 v87, v205, v201, s97
v_perm_b32 v103, v204, v200, s96
v_perm_b32 v201, v206, v202, s97
v_perm_b32 v95, v206, v202, s96
v_cndmask_b32_e64 v103, v103, v201, s[100:101]
s_mov_b32 s19, 60160
buffer_load_dwordx3 v[220:222], v2, s[52:55], s19 offen
s_waitcnt vmcnt(9)
v_perm_b32 v195, v236, v232, s96
v_perm_b32 v199, v236, v232, s97
v_perm_b32 v203, v237, v233, s96
v_perm_b32 v207, v237, v233, s97
v_perm_b32 v211, v238, v234, s96
v_perm_b32 v215, v238, v234, s97
buffer_load_dwordx3 v[232:234], v1, s[44:47], s18 offen nt
s_add_u32 s18, s18, 12288
s_cmp_eq_u32 s18, 1572864
s_cselect_b32 s18, 0, s18
buffer_load_dwordx3 v[236:238], v1, s[44:47], s18 offen nt
s_add_u32 s18, s18, 12288
s_cmp_eq_u32 s18, 1572864
s_cselect_b32 s18, 0, s18
v_dot2c_f32_bf16 v219, v195, v25
v_dot2c_f32_bf16 v223, v199, v25
v_dot2c_f32_bf16 v227, v203, v25
v_dot2c_f32_bf16 v231, v207, v25
v_dot2c_f32_bf16 v235, v211, v25
v_dot2c_f32_bf16 v239, v215, v25
s_waitcnt vmcnt(8)
v_perm_b32 v195, v244, v240, s96
v_perm_b32 v199, v244, v240, s97
v_perm_b32 v203, v245, v241, s96
v_perm_b32 v207, v245, v241, s97
v_perm_b32 v211, v246, v242, s96
v_perm_b32 v215, v246, v242, s97
buffer_load_dwordx3 v[240:242], v1, s[44:47], s18 offen nt
s_add_u32 s18, s18, 12288
s_cmp_eq_u32 s18, 1572864
s_cselect_b32 s18, 0, s18
buffer_load_dwordx3 v[244:246], v1, s[44:47], s18 offen nt
s_add_u32 s18, s18, 12288
s_cmp_eq_u32 s18, 1572864
s_cselect_b32 s18, 0, s18
v_dot2c_f32_bf16 v219, v195, v26
v_dot2c_f32_bf16 v223, v199, v26
v_dot2c_f32_bf16 v227, v203, v26
v_dot2c_f32_bf16 v231, v207, v26
v_dot2c_f32_bf16 v235, v211, v26
v_dot2c_f32_bf16 v239, v215, v26
s_waitcnt vmcnt(8)
v_perm_b32 v195, v252, v248, s96
v_perm_b32 v199, v252, v248, s97
v_perm_b32 v203, v253, v249, s96
v_perm_b32 v207, v253, v249, s97
v_perm_b32 v211, v254, v250, s96
v_perm_b32 v215, v254, v250, s97
buffer_load_dwordx3 v[248:250], v1, s[44:47], s18 offen nt
s_add_u32 s18, s18, 12288
s_cmp_eq_u32 s18, 1572864
s_cselect_b32 s18, 0, s18
buffer_load_dwordx3 v[252:254], v1, s[44:47], s18 offen nt
s_add_u32 s18, s18, 12288
s_cmp_eq_u32 s18, 1572864
s_cselect_b32 s18, 0, s18
v_dot2c_f32_bf16 v219, v195, v27
v_dot2c_f32_bf16 v223, v199, v27
v_dot2c_f32_bf16 v227, v203, v27
v_dot2c_f32_bf16 v231, v207, v27
v_dot2c_f32_bf16 v235, v211, v27
v_dot2c_f32_bf16 v239, v215, v27
ds_read_b128 v[24:27], v11 offset:17584
v_perm_b32 v111, v212, v208, s97
v_perm_b32 v119, v213, v209, s96
v_perm_b32 v127, v213, v209, s97
v_perm_b32 v143, v212, v208, s96
v_perm_b32 v209, v214, v210, s97
v_perm_b32 v135, v214, v210, s96
v_cndmask_b32_e64 v143, v143, v209, s[100:101]
s_barrier
s_waitcnt vmcnt(7)
v_perm_b32 v195, v228, v224, s96
v_perm_b32 v199, v228, v224, s97
v_perm_b32 v203, v229, v225, s96
v_perm_b32 v207, v229, v225, s97
v_perm_b32 v211, v230, v226, s96
v_perm_b32 v215, v230, v226, s97
buffer_load_dwordx3 v[224:226], v1, s[44:47], s18 offen nt
s_add_u32 s18, s18, 12288
s_cmp_eq_u32 s18, 1572864
s_cselect_b32 s18, 0, s18
buffer_load_dwordx3 v[228:230], v1, s[44:47], s18 offen nt
s_add_u32 s18, s18, 12288
s_cmp_eq_u32 s18, 1572864
s_cselect_b32 s18, 0, s18
s_waitcnt lgkmcnt(1)
v_dot2c_f32_bf16 v219, v195, v4
v_dot2c_f32_bf16 v223, v199, v4
v_dot2c_f32_bf16 v227, v203, v4
v_dot2c_f32_bf16 v231, v207, v4
v_dot2c_f32_bf16 v235, v211, v4
v_dot2c_f32_bf16 v239, v215, v4
s_waitcnt vmcnt(6)
v_perm_b32 v195, v236, v232, s96
v_perm_b32 v199, v236, v232, s97
v_perm_b32 v203, v237, v233, s96
v_perm_b32 v207, v237, v233, s97
v_perm_b32 v211, v238, v234, s96
v_perm_b32 v215, v238, v234, s97
buffer_load_dwordx3 v[232:234], v1, s[44:47], s18 offen nt
s_add_u32 s18, s18, 12288
s_cmp_eq_u32 s18, 1572864
s_cselect_b32 s18, 0, s18
buffer_load_dwordx3 v[236:238], v1, s[44:47], s18 offen nt
s_add_u32 s18, s18, 12288
s_cmp_eq_u32 s18, 1572864
s_cselect_b32 s18, 0, s18
v_dot2c_f32_bf16 v219, v195, v5
v_dot2c_f32_bf16 v223, v199, v5
v_dot2c_f32_bf16 v227, v203, v5
v_dot2c_f32_bf16 v231, v207, v5
v_dot2c_f32_bf16 v235, v211, v5
v_dot2c_f32_bf16 v239, v215, v5
s_waitcnt vmcnt(6)
v_perm_b32 v195, v244, v240, s96
v_perm_b32 v199, v244, v240, s97
v_perm_b32 v203, v245, v241, s96
v_perm_b32 v207, v245, v241, s97
v_perm_b32 v211, v246, v242, s96
v_perm_b32 v215, v246, v242, s97
buffer_load_dwordx3 v[240:242], v1, s[44:47], s18 offen nt
s_add_u32 s18, s18, 12288
s_cmp_eq_u32 s18, 1572864
s_cselect_b32 s18, 0, s18
buffer_load_dwordx3 v[244:246], v1, s[44:47], s18 offen nt
s_add_u32 s18, s18, 12288
s_cmp_eq_u32 s18, 1572864
s_cselect_b32 s18, 0, s18
v_dot2c_f32_bf16 v219, v195, v6
v_dot2c_f32_bf16 v223, v199, v6
v_dot2c_f32_bf16 v227, v203, v6
v_dot2c_f32_bf16 v231, v207, v6
v_dot2c_f32_bf16 v235, v211, v6
v_dot2c_f32_bf16 v239, v215, v6
v_perm_b32 v151, v220, v216, s97
v_perm_b32 v159, v221, v217, s96
v_perm_b32 v167, v221, v217, s97
v_perm_b32 v183, v220, v216, s96
v_perm_b32 v217, v222, v218, s97
v_perm_b32 v175, v222, v218, s96
v_cndmask_b32_e64 v183, v183, v217, s[100:101]
s_waitcnt vmcnt(6)
v_perm_b32 v195, v252, v248, s96
v_perm_b32 v199, v252, v248, s97
v_perm_b32 v203, v253, v249, s96
v_perm_b32 v207, v253, v249, s97
v_perm_b32 v211, v254, v250, s96
v_perm_b32 v215, v254, v250, s97
buffer_load_dwordx3 v[248:250], v1, s[44:47], s18 offen nt
s_add_u32 s18, s18, 12288
s_cmp_eq_u32 s18, 1572864
s_cselect_b32 s18, 0, s18
buffer_load_dwordx3 v[252:254], v1, s[44:47], s18 offen nt
s_add_u32 s18, s18, 12288
s_cmp_eq_u32 s18, 1572864
s_cselect_b32 s18, 0, s18
v_dot2c_f32_bf16 v219, v195, v7
v_dot2c_f32_bf16 v223, v199, v7
v_dot2c_f32_bf16 v227, v203, v7
v_dot2c_f32_bf16 v231, v207, v7
v_dot2c_f32_bf16 v235, v211, v7
v_dot2c_f32_bf16 v239, v215, v7
ds_read_b128 v[4:7], v11 offset:17600
s_waitcnt vmcnt(6)
v_perm_b32 v195, v228, v224, s96
v_perm_b32 v199, v228, v224, s97
v_perm_b32 v203, v229, v225, s96
v_perm_b32 v207, v229, v225, s97
v_perm_b32 v211, v230, v226, s96
v_perm_b32 v215, v230, v226, s97
buffer_load_dwordx3 v[224:226], v1, s[44:47], s18 offen nt
s_add_u32 s18, s18, 12288
s_cmp_eq_u32 s18, 1572864
s_cselect_b32 s18, 0, s18
buffer_load_dwordx3 v[228:230], v1, s[44:47], s18 offen nt
s_add_u32 s18, s18, 12288
s_cmp_eq_u32 s18, 1572864
s_cselect_b32 s18, 0, s18
s_waitcnt lgkmcnt(1)
v_dot2c_f32_bf16 v219, v195, v24
v_dot2c_f32_bf16 v223, v199, v24
v_dot2c_f32_bf16 v227, v203, v24
v_dot2c_f32_bf16 v231, v207, v24
v_dot2c_f32_bf16 v235, v211, v24
v_dot2c_f32_bf16 v239, v215, v24
s_waitcnt vmcnt(6)
v_perm_b32 v195, v236, v232, s96
v_perm_b32 v199, v236, v232, s97
v_perm_b32 v203, v237, v233, s96
v_perm_b32 v207, v237, v233, s97
v_perm_b32 v211, v238, v234, s96
v_perm_b32 v215, v238, v234, s97
buffer_load_dwordx3 v[232:234], v1, s[44:47], s18 offen nt
s_add_u32 s18, s18, 12288
s_cmp_eq_u32 s18, 1572864
s_cselect_b32 s18, 0, s18
buffer_load_dwordx3 v[236:238], v1, s[44:47], s18 offen nt
s_add_u32 s18, s18, 12288
s_cmp_eq_u32 s18, 1572864
s_cselect_b32 s18, 0, s18
v_dot2c_f32_bf16 v219, v195, v25
v_dot2c_f32_bf16 v223, v199, v25
v_dot2c_f32_bf16 v227, v203, v25
v_dot2c_f32_bf16 v231, v207, v25
v_dot2c_f32_bf16 v235, v211, v25
v_dot2c_f32_bf16 v239, v215, v25
s_waitcnt vmcnt(6)
v_perm_b32 v195, v244, v240, s96
v_perm_b32 v199, v244, v240, s97
v_perm_b32 v203, v245, v241, s96
v_perm_b32 v207, v245, v241, s97
v_perm_b32 v211, v246, v242, s96
v_perm_b32 v215, v246, v242, s97
buffer_load_dwordx3 v[240:242], v1, s[44:47], s18 offen nt
s_add_u32 s18, s18, 12288
s_cmp_eq_u32 s18, 1572864
s_cselect_b32 s18, 0, s18
buffer_load_dwordx3 v[244:246], v1, s[44:47], s18 offen nt
s_add_u32 s18, s18, 12288
s_cmp_eq_u32 s18, 1572864
s_cselect_b32 s18, 0, s18
v_dot2c_f32_bf16 v219, v195, v26
v_dot2c_f32_bf16 v223, v199, v26
v_dot2c_f32_bf16 v227, v203, v26
v_dot2c_f32_bf16 v231, v207, v26
v_dot2c_f32_bf16 v235, v211, v26
v_dot2c_f32_bf16 v239, v215, v26
s_waitcnt vmcnt(6)
v_perm_b32 v195, v252, v248, s96
v_perm_b32 v199, v252, v248, s97
v_perm_b32 v203, v253, v249, s96
v_perm_b32 v207, v253, v249, s97
v_perm_b32 v211, v254, v250, s96
v_perm_b32 v215, v254, v250, s97
buffer_load_dwordx3 v[248:250], v1, s[44:47], s18 offen nt
s_add_u32 s18, s18, 12288
s_cmp_eq_u32 s18, 1572864
s_cselect_b32 s18, 0, s18
buffer_load_dwordx3 v[252:254], v1, s[44:47], s18 offen nt
s_add_u32 s18, s18, 12288
s_cmp_eq_u32 s18, 1572864
s_cselect_b32 s18, 0, s18
v_dot2c_f32_bf16 v219, v195, v27
v_dot2c_f32_bf16 v223, v199, v27
v_dot2c_f32_bf16 v227, v203, v27
v_dot2c_f32_bf16 v231, v207, v27
v_dot2c_f32_bf16 v235, v211, v27
v_dot2c_f32_bf16 v239, v215, v27
ds_read_b128 v[24:27], v11 offset:17616
s_barrier
s_waitcnt vmcnt(6)
v_perm_b32 v195, v228, v224, s96
v_perm_b32 v199, v228, v224, s97
v_perm_b32 v203, v229, v225, s96
v_perm_b32 v207, v229, v225, s97
v_perm_b32 v211, v230, v226, s96
v_perm_b32 v215, v230, v226, s97
buffer_load_dwordx3 v[224:226], v1, s[44:47], s18 offen nt
s_add_u32 s18, s18, 12288
s_cmp_eq_u32 s18, 1572864
s_cselect_b32 s18, 0, s18
buffer_load_dwordx3 v[228:230], v1, s[44:47], s18 offen nt
s_add_u32 s18, s18, 12288
s_cmp_eq_u32 s18, 1572864
s_cselect_b32 s18, 0, s18
s_waitcnt lgkmcnt(1)
v_dot2c_f32_bf16 v219, v195, v4
v_dot2c_f32_bf16 v223, v199, v4
v_dot2c_f32_bf16 v227, v203, v4
v_dot2c_f32_bf16 v231, v207, v4
v_dot2c_f32_bf16 v235, v211, v4
v_dot2c_f32_bf16 v239, v215, v4
s_waitcnt vmcnt(6)
v_perm_b32 v195, v236, v232, s96
v_perm_b32 v199, v236, v232, s97
v_perm_b32 v203, v237, v233, s96
v_perm_b32 v207, v237, v233, s97
v_perm_b32 v211, v238, v234, s96
v_perm_b32 v215, v238, v234, s97
buffer_load_dwordx3 v[232:234], v1, s[44:47], s18 offen nt
s_add_u32 s18, s18, 12288
s_cmp_eq_u32 s18, 1572864
s_cselect_b32 s18, 0, s18
buffer_load_dwordx3 v[236:238], v1, s[44:47], s18 offen nt
s_add_u32 s18, s18, 12288
s_cmp_eq_u32 s18, 1572864
s_cselect_b32 s18, 0, s18
v_dot2c_f32_bf16 v219, v195, v5
v_dot2c_f32_bf16 v223, v199, v5
v_dot2c_f32_bf16 v227, v203, v5
v_dot2c_f32_bf16 v231, v207, v5
v_dot2c_f32_bf16 v235, v211, v5
v_dot2c_f32_bf16 v239, v215, v5
s_waitcnt vmcnt(6)
v_perm_b32 v195, v244, v240, s96
v_perm_b32 v199, v244, v240, s97
v_perm_b32 v203, v245, v241, s96
v_perm_b32 v207, v245, v241, s97
v_perm_b32 v211, v246, v242, s96
v_perm_b32 v215, v246, v242, s97
buffer_load_dwordx3 v[240:242], v1, s[44:47], s18 offen nt
s_add_u32 s18, s18, 12288
s_cmp_eq_u32 s18, 1572864
s_cselect_b32 s18, 0, s18
buffer_load_dwordx3 v[244:246], v1, s[44:47], s18 offen nt
s_add_u32 s18, s18, 12288
s_cmp_eq_u32 s18, 1572864
s_cselect_b32 s18, 0, s18
v_dot2c_f32_bf16 v219, v195, v6
v_dot2c_f32_bf16 v223, v199, v6
v_dot2c_f32_bf16 v227, v203, v6
v_dot2c_f32_bf16 v231, v207, v6
v_dot2c_f32_bf16 v235, v211, v6
v_dot2c_f32_bf16 v239, v215, v6
v_max_u32 v243, v8, v9
v_cmp_eq_u32 vcc, -1, v243
s_nop 4
s_cbranch_vccnz L_ml_slow
L_ml_ok:
v_mov_b32 v243, v8
s_nop 1
v_max_f32_dpp v243, v243, v243 quad_perm:[1,0,3,2] row_mask:0xf bank_mask:0xf
s_nop 1
v_max_f32_dpp v243, v243, v243 quad_perm:[2,3,0,1] row_mask:0xf bank_mask:0xf
s_nop 1
v_max_f32_dpp v243, v243, v243 row_half_mirror row_mask:0xf bank_mask:0xf
s_nop 1
v_max_f32_dpp v243, v243, v243 row_mirror row_mask:0xf bank_mask:0xf
v_sub_f32 v8, v8, v243
v_mul_f32 v8, 0x3fb8aa3b, v8
v_exp_f32 v8, v8
s_nop 0
v_mul_f32 v8, v8, v9
s_nop 1
v_add_f32_dpp v8, v8, v8 quad_perm:[1,0,3,2] row_mask:0xf bank_mask:0xf
s_nop 1
v_add_f32_dpp v8, v8, v8 quad_perm:[2,3,0,1] row_mask:0xf bank_mask:0xf
s_nop 1
v_add_f32_dpp v8, v8, v8 row_half_mirror row_mask:0xf bank_mask:0xf
s_nop 1
v_add_f32_dpp v8, v8, v8 row_mirror row_mask:0xf bank_mask:0xf
v_sub_f32 v243, s20, v243
v_mul_f32 v243, 0x3fb8aa3b, v243
v_exp_f32 v243, v243
v_rcp_f32 v8, v8
s_nop 0
v_mul_f32 v243, v243, v8
v_mul_f32 v243, s22, v243
s_nop 0
v_readfirstlane_b32 s24, v243
s_lshl_b32 s13, s3, 5
v_and_b32 v8, 8, v0
v_add_u32 v8, s13, v8
v_and_b32 v9, 17, v0
v_lshl_add_u32 v8, v9, 4, v8
v_and_b32 v9, 2, v0
v_lshl_add_u32 v8, v9, 1, v8
v_and_b32 v9, 4, v0
v_lshl_add_u32 v8, v9, 7, v8
v_lshrrev_b32 v243, 5, v0
v_lshl_add_u32 v9, v243, 1, v8
v_lshl_add_u32 v8, v243, 10, v8
v_mov_b32 v29, 0x44444444
v_mov_b32 v243, 0xeeeeeeee
v_cndmask_b32_e64 v29, v29, v243, s[100:101]
s_lshr_b32 s9, s2, 3
s_and_b32 s8, s2, 1
s_mul_i32 s8, s8, 20
s_add_u32 s9, s9, s8
s_bfe_u32 s8, s2, 0x20001
s_mul_i32 s13, s8, 163840
s_lshl_b32 s14, s9, 6
s_add_u32 s13, s13, s14
s_add_u32 s88, s38, s13
s_addc_u32 s89, s39, 0
s_mov_b32 s90, 161344
s_mov_b32 s91, 0x20000
s_mul_i32 s13, s8, 1280
s_mul_i32 s14, s9, 52
s_lshr_b32 s14, s14, 8
s_mul_i32 s8, s14, 5
s_sub_u32 s9, s9, s8
s_mul_i32 s14, s14, 160
s_add_u32 s13, s13, s14
s_add_u32 s92, s34, s13
s_addc_u32 s93, s35, 0
s_mov_b32 s94, 160
s_mov_b32 s95, 0x20000
v_lshrrev_b32 v20, 2, v0
v_mul_u32_u24 v20, 2560, v20
v_and_b32 v21, 3, v0
v_lshl_add_u32 v20, v21, 4, v20
v_lshrrev_b32 v22, 4, v0
v_lshl_add_u32 v21, v21, 2, v22
s_cmp_lt_u32 s9, 4
s_cselect_b32 s8, -2, 8
s_lshl_b32 s9, s9, 2
s_lshr_b32 s9, 0x8462, s9
s_and_b32 s9, s9, 15
v_and_b32 v22, 1, v22
v_mul_u32_u24 v21, 10, v21
v_mad_i32_i24 v21, v22, s8, v21
v_add_u32 v21, s9, v21
s_mov_b32 s25, 40960
s_mov_b32 s26, 81920
s_mov_b32 s27, 122880
s_mov_b32 s28, 200000
s_waitcnt vmcnt(6)
v_perm_b32 v195, v252, v248, s96
v_perm_b32 v199, v252, v248, s97
v_perm_b32 v203, v253, v249, s96
v_perm_b32 v207, v253, v249, s97
v_perm_b32 v211, v254, v250, s96
v_perm_b32 v215, v254, v250, s97
buffer_load_dwordx3 v[248:250], v1, s[44:47], s18 offen nt
s_add_u32 s18, s18, 12288
s_cmp_eq_u32 s18, 1572864
s_cselect_b32 s18, 0, s18
buffer_load_dwordx3 v[252:254], v1, s[44:47], s18 offen nt
s_add_u32 s18, s18, 12288
s_cmp_eq_u32 s18, 1572864
s_cselect_b32 s18, 0, s18
v_dot2c_f32_bf16 v219, v195, v7
v_dot2c_f32_bf16 v223, v199, v7
v_dot2c_f32_bf16 v227, v203, v7
v_dot2c_f32_bf16 v231, v207, v7
v_dot2c_f32_bf16 v235, v211, v7
v_dot2c_f32_bf16 v239, v215, v7
ds_read_b128 v[4:7], v11 offset:17632
s_waitcnt vmcnt(6)
v_perm_b32 v195, v228, v224, s96
v_perm_b32 v199, v228, v224, s97
v_perm_b32 v203, v229, v225, s96
v_perm_b32 v207, v229, v225, s97
v_perm_b32 v211, v230, v226, s96
v_perm_b32 v215, v230, v226, s97
buffer_load_dwordx3 v[224:226], v1, s[44:47], s18 offen nt
s_add_u32 s18, s18, 12288
s_cmp_eq_u32 s18, 1572864
s_cselect_b32 s18, 0, s18
buffer_load_dwordx3 v[228:230], v1, s[44:47], s18 offen nt
s_add_u32 s18, s18, 12288
s_cmp_eq_u32 s18, 1572864
s_cselect_b32 s18, 0, s18
s_waitcnt lgkmcnt(1)
v_dot2c_f32_bf16 v219, v195, v24
v_dot2c_f32_bf16 v223, v199, v24
v_dot2c_f32_bf16 v227, v203, v24
v_dot2c_f32_bf16 v231, v207, v24
v_dot2c_f32_bf16 v235, v211, v24
v_dot2c_f32_bf16 v239, v215, v24
s_waitcnt vmcnt(6)
v_perm_b32 v195, v236, v232, s96
v_perm_b32 v199, v236, v232, s97
v_perm_b32 v203, v237, v233, s96
v_perm_b32 v207, v237, v233, s97
v_perm_b32 v211, v238, v234, s96
v_perm_b32 v215, v238, v234, s97
buffer_load_dwordx3 v[232:234], v1, s[44:47], s18 offen nt
s_add_u32 s18, s18, 12288
s_cmp_eq_u32 s18, 1572864
s_cselect_b32 s18, 0, s18
buffer_load_dwordx3 v[236:238], v1, s[44:47], s18 offen nt
s_add_u32 s18, s18, 12288
s_cmp_eq_u32 s18, 1572864
s_cselect_b32 s18, 0, s18
v_dot2c_f32_bf16 v219, v195, v25
v_dot2c_f32_bf16 v223, v199, v25
v_dot2c_f32_bf16 v227, v203, v25
v_dot2c_f32_bf16 v231, v207, v25
v_dot2c_f32_bf16 v235, v211, v25
v_dot2c_f32_bf16 v239, v215, v25
s_waitcnt vmcnt(6)
v_perm_b32 v195, v244, v240, s96
v_perm_b32 v199, v244, v240, s97
v_perm_b32 v203, v245, v241, s96
v_perm_b32 v207, v245, v241, s97
v_perm_b32 v211, v246, v242, s96
v_perm_b32 v215, v246, v242, s97
buffer_load_dwordx3 v[240:242], v1, s[44:47], s18 offen nt
s_add_u32 s18, s18, 12288
s_cmp_eq_u32 s18, 1572864
s_cselect_b32 s18, 0, s18
buffer_load_dwordx3 v[244:246], v1, s[44:47], s18 offen nt
s_add_u32 s18, s18, 12288
s_cmp_eq_u32 s18, 1572864
s_cselect_b32 s18, 0, s18
v_dot2c_f32_bf16 v219, v195, v26
v_dot2c_f32_bf16 v223, v199, v26
v_dot2c_f32_bf16 v227, v203, v26
v_dot2c_f32_bf16 v231, v207, v26
v_dot2c_f32_bf16 v235, v211, v26
v_dot2c_f32_bf16 v239, v215, v26
s_waitcnt vmcnt(6)
v_perm_b32 v195, v252, v248, s96
v_perm_b32 v199, v252, v248, s97
v_perm_b32 v203, v253, v249, s96
v_perm_b32 v207, v253, v249, s97
v_perm_b32 v211, v254, v250, s96
v_perm_b32 v215, v254, v250, s97
buffer_load_dwordx3 v[248:250], v1, s[44:47], s18 offen nt
s_add_u32 s18, s18, 12288
s_cmp_eq_u32 s18, 1572864
s_cselect_b32 s18, 0, s18
buffer_load_dwordx3 v[252:254], v1, s[44:47], s18 offen nt
s_add_u32 s18, s18, 12288
s_cmp_eq_u32 s18, 1572864
s_cselect_b32 s18, 0, s18
v_dot2c_f32_bf16 v219, v195, v27
v_dot2c_f32_bf16 v223, v199, v27
v_dot2c_f32_bf16 v227, v203, v27
v_dot2c_f32_bf16 v231, v207, v27
v_dot2c_f32_bf16 v235, v211, v27
v_dot2c_f32_bf16 v239, v215, v27
ds_read_b128 v[24:27], v11 offset:17648
s_barrier
s_waitcnt vmcnt(6)
v_perm_b32 v195, v228, v224, s96
v_perm_b32 v199, v228, v224, s97
v_perm_b32 v203, v229, v225, s96
v_perm_b32 v207, v229, v225, s97
v_perm_b32 v211, v230, v226, s96
v_perm_b32 v215, v230, v226, s97
buffer_load_dwordx3 v[224:226], v1, s[44:47], s18 offen nt
s_add_u32 s18, s18, 12288
s_cmp_eq_u32 s18, 1572864
s_cselect_b32 s18, 0, s18
buffer_load_dwordx3 v[228:230], v1, s[44:47], s18 offen nt
s_add_u32 s18, s18, 12288
s_cmp_eq_u32 s18, 1572864
s_cselect_b32 s18, 0, s18
s_waitcnt lgkmcnt(1)
v_dot2c_f32_bf16 v219, v195, v4
v_dot2c_f32_bf16 v223, v199, v4
v_dot2c_f32_bf16 v227, v203, v4
v_dot2c_f32_bf16 v231, v207, v4
v_dot2c_f32_bf16 v235, v211, v4
v_dot2c_f32_bf16 v239, v215, v4
s_waitcnt vmcnt(6)
v_perm_b32 v195, v236, v232, s96
v_perm_b32 v199, v236, v232, s97
v_perm_b32 v203, v237, v233, s96
v_perm_b32 v207, v237, v233, s97
v_perm_b32 v211, v238, v234, s96
v_perm_b32 v215, v238, v234, s97
buffer_load_dwordx3 v[232:234], v1, s[44:47], s18 offen nt
s_add_u32 s18, s18, 12288
s_cmp_eq_u32 s18, 1572864
s_cselect_b32 s18, 0, s18
buffer_load_dwordx3 v[236:238], v1, s[44:47], s18 offen nt
s_add_u32 s18, s18, 12288
s_cmp_eq_u32 s18, 1572864
s_cselect_b32 s18, 0, s18
v_dot2c_f32_bf16 v219, v195, v5
v_dot2c_f32_bf16 v223, v199, v5
v_dot2c_f32_bf16 v227, v203, v5
v_dot2c_f32_bf16 v231, v207, v5
v_dot2c_f32_bf16 v235, v211, v5
v_dot2c_f32_bf16 v239, v215, v5
s_waitcnt vmcnt(6)
v_perm_b32 v195, v244, v240, s96
v_perm_b32 v199, v244, v240, s97
v_perm_b32 v203, v245, v241, s96
v_perm_b32 v207, v245, v241, s97
v_perm_b32 v211, v246, v242, s96
v_perm_b32 v215, v246, v242, s97
buffer_load_dwordx3 v[240:242], v1, s[44:47], s18 offen nt
s_add_u32 s18, s18, 12288
s_cmp_eq_u32 s18, 1572864
s_cselect_b32 s18, 0, s18
buffer_load_dwordx3 v[244:246], v1, s[44:47], s18 offen nt
s_add_u32 s18, s18, 12288
s_cmp_eq_u32 s18, 1572864
s_cselect_b32 s18, 0, s18
v_dot2c_f32_bf16 v219, v195, v6
v_dot2c_f32_bf16 v223, v199, v6
v_dot2c_f32_bf16 v227, v203, v6
v_dot2c_f32_bf16 v231, v207, v6
v_dot2c_f32_bf16 v235, v211, v6
v_dot2c_f32_bf16 v239, v215, v6
s_waitcnt vmcnt(6)
v_perm_b32 v195, v252, v248, s96
v_perm_b32 v199, v252, v248, s97
v_perm_b32 v203, v253, v249, s96
v_perm_b32 v207, v253, v249, s97
v_perm_b32 v211, v254, v250, s96
v_perm_b32 v215, v254, v250, s97
buffer_load_dwordx3 v[248:250], v1, s[44:47], s18 offen nt
s_add_u32 s18, s18, 12288
s_cmp_eq_u32 s18, 1572864
s_cselect_b32 s18, 0, s18
buffer_load_dwordx3 v[252:254], v1, s[44:47], s18 offen nt
v_dot2c_f32_bf16 v219, v195, v7
v_dot2c_f32_bf16 v223, v199, v7
v_dot2c_f32_bf16 v227, v203, v7
v_dot2c_f32_bf16 v231, v207, v7
v_dot2c_f32_bf16 v235, v211, v7
v_dot2c_f32_bf16 v239, v215, v7
s_waitcnt vmcnt(6)
v_perm_b32 v195, v228, v224, s96
v_perm_b32 v199, v228, v224, s97
v_perm_b32 v203, v229, v225, s96
v_perm_b32 v207, v229, v225, s97
v_perm_b32 v211, v230, v226, s96
v_perm_b32 v215, v230, v226, s97
s_waitcnt lgkmcnt(0)
v_dot2c_f32_bf16 v219, v195, v24
v_dot2c_f32_bf16 v223, v199, v24
v_dot2c_f32_bf16 v227, v203, v24
v_dot2c_f32_bf16 v231, v207, v24
v_dot2c_f32_bf16 v235, v211, v24
v_dot2c_f32_bf16 v239, v215, v24
s_waitcnt vmcnt(4)
v_perm_b32 v195, v236, v232, s96
v_perm_b32 v199, v236, v232, s97
v_perm_b32 v203, v237, v233, s96
v_perm_b32 v207, v237, v233, s97
v_perm_b32 v211, v238, v234, s96
v_perm_b32 v215, v238, v234, s97
v_dot2c_f32_bf16 v219, v195, v25
v_dot2c_f32_bf16 v223, v199, v25
v_dot2c_f32_bf16 v227, v203, v25
v_dot2c_f32_bf16 v231, v207, v25
v_dot2c_f32_bf16 v235, v211, v25
v_dot2c_f32_bf16 v239, v215, v25
s_waitcnt vmcnt(2)
v_perm_b32 v195, v244, v240, s96
v_perm_b32 v199, v244, v240, s97
v_perm_b32 v203, v245, v241, s96
v_perm_b32 v207, v245, v241, s97
v_perm_b32 v211, v246, v242, s96
v_perm_b32 v215, v246, v242, s97
v_dot2c_f32_bf16 v219, v195, v26
v_dot2c_f32_bf16 v223, v199, v26
v_dot2c_f32_bf16 v227, v203, v26
v_dot2c_f32_bf16 v231, v207, v26
v_dot2c_f32_bf16 v235, v211, v26
v_dot2c_f32_bf16 v239, v215, v26
s_waitcnt vmcnt(0)
v_perm_b32 v195, v252, v248, s96
v_perm_b32 v199, v252, v248, s97
v_perm_b32 v203, v253, v249, s96
v_perm_b32 v207, v253, v249, s97
v_perm_b32 v211, v254, v250, s96
v_perm_b32 v215, v254, v250, s97
v_dot2c_f32_bf16 v219, v195, v27
v_dot2c_f32_bf16 v223, v199, v27
v_dot2c_f32_bf16 v227, v203, v27
v_dot2c_f32_bf16 v231, v207, v27
v_dot2c_f32_bf16 v235, v211, v27
v_dot2c_f32_bf16 v239, v215, v27
s_nop 0
v_permlane32_swap_b32 v219, v231
v_permlane32_swap_b32 v223, v235
v_permlane32_swap_b32 v227, v239
v_add_f32 v219, v219, v231
v_add_f32 v223, v223, v235
v_add_f32 v227, v227, v239
v_mul_f32 v4, s24, v219
v_mul_f32 v5, s24, v223
v_mul_f32 v6, s24, v227
v_cvt_pk_bf16_f32 v4, v4, v5
v_cvt_pk_bf16_f32 v5, v6, v6
ds_write_b32 v8, v4 offset:8192
ds_write_b16 v9, v5 offset:10240
s_waitcnt lgkmcnt(0)
s_barrier
ds_read_b128 v[52:55], v10 offset:8192
ds_read_b128 v[56:59], v10 offset:9216
ds_read_b128 v[60:63], v10 offset:10240
s_waitcnt lgkmcnt(2)
v_smfmac_f32_16x16x64_bf16 v[48:51], v[52:55], v[96:103], v29
v_smfmac_f32_16x16x64_bf16 v[32:35], v[52:55], v[64:71], v29
v_smfmac_f32_16x16x64_bf16 v[36:39], v[52:55], v[72:79], v29
v_smfmac_f32_16x16x64_bf16 v[40:43], v[52:55], v[80:87], v29
v_smfmac_f32_16x16x64_bf16 v[44:47], v[52:55], v[88:95], v29
s_waitcnt lgkmcnt(1)
v_smfmac_f32_16x16x64_bf16 v[48:51], v[56:59], v[136:143], v29
v_smfmac_f32_16x16x64_bf16 v[32:35], v[56:59], v[104:111], v29
v_smfmac_f32_16x16x64_bf16 v[36:39], v[56:59], v[112:119], v29
v_smfmac_f32_16x16x64_bf16 v[40:43], v[56:59], v[120:127], v29
v_smfmac_f32_16x16x64_bf16 v[44:47], v[56:59], v[128:135], v29
s_waitcnt lgkmcnt(0)
v_smfmac_f32_16x16x64_bf16 v[48:51], v[60:63], v[176:183], v29
v_smfmac_f32_16x16x64_bf16 v[32:35], v[60:63], v[144:151], v29
v_smfmac_f32_16x16x64_bf16 v[36:39], v[60:63], v[152:159], v29
v_smfmac_f32_16x16x64_bf16 v[40:43], v[60:63], v[160:167], v29
v_smfmac_f32_16x16x64_bf16 v[44:47], v[60:63], v[168:175], v29
s_nop 3
v_pk_add_f32 v[48:49], v[48:49], v[50:51]
v_pk_add_f32 v[32:33], v[32:33], v[34:35]
v_pk_add_f32 v[36:37], v[36:37], v[38:39]
v_pk_add_f32 v[40:41], v[40:41], v[42:43]
v_pk_add_f32 v[44:45], v[44:45], v[46:47]
v_add_f32 v50, v48, v49
v_add_f32 v48, v48, v49
v_add_f32 v32, v32, v33
v_add_f32 v36, v36, v37
v_add_f32 v40, v40, v41
v_add_f32 v44, v44, v45
v_permlane32_swap_b32 v48, v50
v_permlane32_swap_b32 v32, v36
v_permlane32_swap_b32 v40, v44
v_add_f32 v49, v48, v50
v_add_f32 v48, v48, v50
v_add_f32 v32, v32, v36
v_add_f32 v40, v40, v44
v_permlane16_swap_b32 v48, v49
s_nop 0
v_permlane16_swap_b32 v32, v40
v_add_f32 v48, v48, v49
v_add_f32 v32, v32, v40
v_min_u32 v48, -2, v48
v_min_u32 v32, -2, v32
buffer_store_dword v32, v31, s[76:79], 0 offen sc1
s_mov_b64 exec, 0xffff
buffer_store_dword v48, v31, s[76:79], 0 offen offset:256 sc1
s_mov_b64 exec, -1
s_cmp_lg_u32 s3, 0
s_cbranch_scc1 L_fin
s_cmp_ge_u32 s2, 160
s_cbranch_scc1 L_fin
L_poll:
buffer_load_dwordx4 v[32:35], v20, s[88:91], 0 offen sc1
buffer_load_dwordx4 v[36:39], v20, s[88:91], s25 offen sc1
buffer_load_dwordx4 v[40:43], v20, s[88:91], s26 offen sc1
buffer_load_dwordx4 v[44:47], v20, s[88:91], s27 offen sc1
s_waitcnt vmcnt(0)
v_max3_u32 v4, v32, v33, v34
v_max3_u32 v4, v4, v35, v36
v_max3_u32 v4, v4, v37, v38
v_max3_u32 v4, v4, v39, v40
v_max3_u32 v4, v4, v41, v42
v_max3_u32 v4, v4, v43, v44
v_max3_u32 v4, v4, v45, v46
v_max_u32 v4, v4, v47
v_cmp_eq_u32 vcc, -1, v4
s_sub_u32 s28, s28, 1
s_cbranch_scc1 L_red
s_nop 2
s_cbranch_vccnz L_poll
L_red:
v_add_f32 v32, v32, v36
v_add_f32 v40, v40, v44
v_add_f32 v33, v33, v37
v_add_f32 v41, v41, v45
v_add_f32 v34, v34, v38
v_add_f32 v42, v42, v46
v_add_f32 v35, v35, v39
v_add_f32 v43, v43, v47
v_add_f32 v32, v32, v40
v_add_f32 v33, v33, v41
v_add_f32 v34, v34, v42
v_add_f32 v35, v35, v43
s_nop 0
v_permlane32_swap_b32 v32, v34
v_permlane32_swap_b32 v33, v35
v_add_f32 v32, v32, v34
v_add_f32 v33, v33, v35
s_nop 1
v_permlane16_swap_b32 v32, v33
v_add_f32 v32, v32, v33
s_nop 1
v_add_f32_dpp v32, v32, v32 row_ror:8 row_mask:0xf bank_mask:0xf
s_nop 1
v_add_f32_dpp v32, v32, v32 row_ror:4 row_mask:0xf bank_mask:0xf
v_cvt_pk_bf16_f32 v32, v32, v32
s_mov_b32 exec_lo, 0x000f000f
s_mov_b32 exec_hi, 0x000f000f
buffer_store_short v32, v21, s[92:95], 0 offen
s_mov_b64 exec, -1
L_fin:
L_end:
s_endpgm
L_flag_slow:
s_mov_b32 s28, 200000
L_flag_loop:
s_sleep 8
v_lshlrev_b32 v28, 2, v0
buffer_load_dword v28, v28, s[84:87], 0 offen sc1
s_waitcnt vmcnt(0)
v_cmp_gt_u32 vcc, s31, v28
s_sub_u32 s28, s28, 1
s_cbranch_scc1 L_flag_ok
s_nop 2
s_cbranch_vccnz L_flag_loop
s_branch L_flag_ok
L_ml_slow:
s_mov_b32 s28, 200000
L_ml_loop:
s_sleep 8
v_lshlrev_b32 v8, 3, v0
buffer_load_dwordx2 v[8:9], v8, s[80:83], 0 offen sc1
s_waitcnt vmcnt(0)
v_max_u32 v243, v8, v9
v_cmp_eq_u32 vcc, -1, v243
s_sub_u32 s28, s28, 1
s_cbranch_scc1 L_ml_ok
s_nop 2
s_cbranch_vccnz L_ml_loop
s_branch L_ml_ok
.section .rodata,"a"
.p2align 6
.amdhsa_kernel gated_mix__gqa_block_cached__dense_activation_silu__decode_kernel
  .amdhsa_next_free_vgpr 256
  .amdhsa_next_free_sgpr 102
  .amdhsa_accum_offset 256
  .amdhsa_group_segment_fixed_size 0
  .amdhsa_kernarg_size 96
  .amdhsa_user_sgpr_count 2
  .amdhsa_user_sgpr_kernarg_segment_ptr 1
  .amdhsa_system_sgpr_workgroup_id_x 1
.end_amdhsa_kernel
```
